```python
import torch

def _softmax(x, axis=-1):
    return torch.softmax(x, dim=axis)
def _gelu(x):
    return torch.nn.functional.gelu(x, approximate="tanh")
def _silu(x):
    return torch.nn.functional.silu(x)
def _sigmoid(x):
    return torch.sigmoid(x)
def _layernorm(x, axis=-1, eps=1e-5):
    m = x.mean(dim=axis, keepdim=True)
    v = x.var(dim=axis, keepdim=True, unbiased=False)
    return (x - m) / torch.sqrt(v + eps)
def _scatter_add(tgt, idx, src, axis=0):
    return tgt.clone().index_add_(axis, idx, src)
def _segment_sum(src, seg, n):
    out = torch.zeros((n,) + src.shape[1:], dtype=src.dtype)
    return out.index_add_(0, seg, src)
def _pad(x, pw):
    flat = tuple(v for pair in reversed(pw) for v in pair)
    return torch.nn.functional.pad(x, flat)

kernel_name = 'standalone__gqa_block_cached__sampling'

def setup_inputs():

    _w = (lambda a: (lambda t: t.to(torch.bfloat16) if t.is_floating_point() else t)(torch.as_tensor(a)))
    B, Sq, D = 32, 16, 1024
    Hq, Hkv, Sk, Dh = 32, 4, 2048, 128
    assert Hq % Hkv == 0, (Hq, Hkv)
    return {
        "x": _w((lambda *s: torch.randn(*s, dtype=torch.bfloat16) * 0.8)(B, Sq, D)),
        "k_cache": _w((lambda *s: torch.randn(*s, dtype=torch.bfloat16) * 0.8)(B, Hkv, Sk, Dh)),
        "v_cache": _w((lambda *s: torch.randn(*s, dtype=torch.bfloat16) * 0.05)(B, Hkv, Sk, Dh)),
        "wq": _w((lambda *s: torch.randn(*s, dtype=torch.bfloat16) * 0.8)(D, Hq * Dh) * (D ** -0.5)),
        "wo": _w((lambda *s: torch.randn(*s, dtype=torch.bfloat16) * 0.05)(Hq * Dh, D) * ((Hq * Dh) ** -0.5)),
    }

def reference(x, k_cache, v_cache, wq, wo):
    B, Sq, D = x.shape
    Hq, Dh = 32, 128
    Hkv = k_cache.shape[1]
    rep = Hq // Hkv
    q = (lambda x, *d: x.permute(*d))((x @ wq).reshape(B, Sq, Hq, Dh), 0, 2, 1, 3)
    k = (lambda x, n, axis: torch.repeat_interleave(x, n, dim=axis))(k_cache, rep, axis=1)
    v = (lambda x, n, axis: torch.repeat_interleave(x, n, dim=axis))(v_cache, rep, axis=1)
    scores = torch.einsum("bhqd,bhkd->bhqk", q, k) * (Dh ** -0.5)
    p = _softmax(scores, axis=-1)
    o = torch.einsum("bhqk,bhkd->bhqd", p, v)
    return (lambda x, *d: x.permute(*d))(o, 0, 2, 1, 3).reshape(B, Sq, Hq * Dh) @ wo
```

```asm
; @launch grid=(256,1,1) block=(256,1,1) lds=163840
.amdgcn_target "amdgcn-amd-amdhsa--gfx950"
.text
.globl standalone__gqa_block_cached__sampling_kernel
.p2align 8
.type standalone__gqa_block_cached__sampling_kernel,@function
standalone__gqa_block_cached__sampling_kernel:
    s_cmp_ge_u32 s2, 256
    s_cbranch_scc1 L_done
    s_load_dwordx16 s[4:19], s[0:1], 0
    v_lshrrev_b32 v72, 6, v0
    v_and_b32 v64, 63, v0
    v_readfirstlane_b32 s52, v72
    s_getpc_b64 s[62:63]
    s_lshr_b32 s64, s2, 3
    s_lshl_b32 s64, s64, 11
    v_lshlrev_b32 v250, 3, v0
    v_add_u32 v250, s64, v250
    v_cmp_gt_u32 vcc, 0x8250, v250
    s_and_b64 exec, exec, vcc
    s_cbranch_execz L_pf_skip
    global_load_dword v251, v250, s[62:63]
L_pf_skip:
    s_mov_b64 exec, -1
    s_and_b32 s62, s2, 7
    s_lshr_b32 s63, s2, 3
    s_and_b32 s58, s63, 1
    s_lshr_b32 s69, s63, 3
    s_bfe_u32 s64, s63, 0x20001
    s_lshl_b32 s54, s62, 2
    s_add_u32 s54, s54, s64
    v_lshrrev_b32 v65, 4, v64
    v_and_b32 v66, 15, v64
    s_lshl_b32 s66, s52, 17
    s_lshl_b32 s65, s54, 8
    s_add_u32 s66, s66, s65
    v_lshlrev_b32 v72, 2, v65
    v_xor_b32 v72, v72, v66
    v_lshlrev_b32 v72, 4, v72
    v_lshl_add_u32 v112, v65, 13, v72
    v_add_u32 v112, s66, v112
    v_add_u32 v113, 31744, v112
    v_xor_b32 v114, 32, v112
    v_add_u32 v115, 95232, v114
    v_add_u32 v114, 63488, v114
    s_lshl_b32 s66, s69, 18
    s_lshl_b32 s65, s52, 16
    s_add_u32 s66, s66, s65
    v_and_b32 v73, 7, v64
    v_xor_b32 v72, v65, v73
    v_lshlrev_b32 v72, 4, v72
    v_lshrrev_b32 v73, 3, v64
    v_lshl_add_u32 v116, v73, 11, v72
    v_add_u32 v116, s66, v116
    v_xor_b32 v117, 64, v116
    v_add_u32 v117, 15360, v117
    v_add_u32 v118, 30720, v116
    v_add_u32 v119, 30720, v117
    s_add_u32 s67, s69, s64
    s_and_b32 s67, s67, 3
    s_lshl_b32 s67, s67, 19
    s_lshr_b32 s66, s63, 1
    s_lshl_b32 s66, s66, 2
    s_add_u32 s66, s66, s52
    s_lshl_b32 s65, s66, 14
    v_and_b32 v72, 7, v64
    v_lshlrev_b32 v72, 4, v72
    v_lshl_add_u32 v131, v73, 11, v72
    v_add_u32 v131, s65, v131
    s_lshl_b32 s66, s66, 13
    s_lshl_b32 s65, s62, 10
    s_add_u32 s66, s66, s65
    v_lshlrev_b32 v130, 4, v64
    v_add_u32 v130, s66, v130
    s_xor_b32 s77, s2, 8
    s_or_b32 s77, s77, s52
    v_mov_b32 v74, 0x2028000
    s_waitcnt lgkmcnt(0)
    s_mov_b32 s32, s10
    s_and_b32 s33, s11, 0xffff
    s_mov_b32 s34, 0x800000
    s_mov_b32 s35, 0x20000
    s_mov_b32 s20, s4
    s_and_b32 s21, s5, 0xffff
    s_mov_b32 s22, 0x100000
    s_mov_b32 s23, 0x20000
    s_mov_b32 s44, s18
    s_and_b32 s45, s19, 0xffff
    s_mov_b32 s46, 0x10000000
    s_mov_b32 s47, 0x20000
    s_mov_b32 s24, s6
    s_and_b32 s25, s7, 0xffff
    s_and_b32 s4, s67, 0x7fffff
    s_lshl_b32 s7, s52, 12
    s_mov_b32 s5, s69
    s_cmp_lg_u32 s77, 0
    s_cbranch_scc1 L_noepoch0
    buffer_load_dword v75, v74, s[44:47], 0 offen sc1
L_noepoch0:
    s_cmp_eq_u32 s58, 1
    s_cbranch_scc0 L_b_first
    s_mul_i32 s6, s52, 15360
    s_add_u32 m0, s6, 102400
    s_mov_b32 s6, 524288
    buffer_load_dwordx4 v130, s[32:35], s6 offen lds
    s_mov_b32 s6, 128
    buffer_load_dwordx4 v131, s[20:23], s6 offen lds
    s_mov_b32 s6, 1048576
    buffer_load_dwordx4 v130, s[32:35], s6 offen lds
    s_mov_b32 s6, 256
    buffer_load_dwordx4 v131, s[20:23], s6 offen lds
    s_mov_b32 s6, 1572864
    buffer_load_dwordx4 v130, s[32:35], s6 offen lds
    s_mov_b32 s6, 384
    buffer_load_dwordx4 v131, s[20:23], s6 offen lds
    s_mov_b32 s6, 2097152
    buffer_load_dwordx4 v130, s[32:35], s6 offen lds
    s_mov_b32 s6, 512
    buffer_load_dwordx4 v131, s[20:23], s6 offen lds
    s_mov_b32 s6, 2621440
    buffer_load_dwordx4 v130, s[32:35], s6 offen lds
    s_mov_b32 s6, 640
    buffer_load_dwordx4 v131, s[20:23], s6 offen lds
    s_branch L_first_done
L_b_first:
    s_add_u32 m0, s7, 32768
    s_or_b32 s6, s4, 0
    buffer_load_dwordx4 v112, s[32:35], s6 offen offset:0 lds
    s_add_u32 s4, s4, 524288
    s_and_b32 s4, s4, 1572864
    buffer_load_dwordx4 v113, s[32:35], s6 offen offset:1024 lds
    buffer_load_dwordx4 v114, s[32:35], s6 offen offset:2048 lds
    buffer_load_dwordx4 v115, s[32:35], s6 offen offset:3072 lds
    s_add_u32 m0, s7, 98304
    s_lshr_b32 s6, s6, 12
    buffer_load_dwordx4 v116, s[20:23], s6 offen offset:0 lds
    buffer_load_dwordx4 v117, s[20:23], s6 offen offset:1024 lds
    buffer_load_dwordx4 v118, s[20:23], s6 offen offset:2048 lds
    buffer_load_dwordx4 v119, s[20:23], s6 offen offset:3072 lds
L_first_done:
    s_lshr_b32 s53, s63, 2
    s_and_b32 s64, s63, 3
    s_xor_b32 s64, s64, 1
    s_lshr_b32 s55, s62, 1
    s_and_b32 s65, s62, 1
    s_lshl_b32 s56, s65, 2
    s_add_u32 s56, s56, s64
    s_lshl_b32 s57, s65, 4
    s_lshr_b32 s65, s63, 1
    s_add_u32 s57, s57, s65
    s_mov_b32 s74, 0x40004000
    s_lshl_b32 s66, s57, 2
    s_add_u32 s66, s66, s55
    s_lshl_b32 s66, s66, 19
    s_mul_i32 s62, s58, 229376
    s_add_u32 s66, s66, s62
    s_cmp_eq_u32 s58, 0
    s_cselect_b32 s68, 28, 36
    s_lshl_b32 s62, s68, 13
    s_add_u32 s65, s66, s62
    s_mov_b32 s26, s65
    s_mov_b32 s27, 0x20000
    s_mov_b32 s28, s8
    s_and_b32 s29, s9, 0xffff
    s_mov_b32 s30, s65
    s_mov_b32 s31, 0x20000
    s_mov_b32 s36, s12
    s_and_b32 s37, s13, 0xffff
    s_mov_b32 s38, 0x800000
    s_mov_b32 s39, 0x20000
    s_mov_b32 s40, s14
    s_and_b32 s41, s15, 0xffff
    s_mov_b32 s42, 0x100000
    s_mov_b32 s43, 0x20000
    s_mov_b32 s48, s16
    s_and_b32 s49, s17, 0xffff
    s_mov_b32 s50, 0x100
    s_mov_b32 s51, 0x20000
    s_cmp_lg_u32 s77, 0
    s_cbranch_scc1 L_noepoch
    s_waitcnt vmcnt(10)
    v_add_u32 v75, 1, v75
    v_max_u32 v75, 1, v75
    s_mov_b64 exec, 1
    buffer_store_dword v75, v74, s[44:47], 0 offen sc1
    v_mov_b32 v74, 0
    buffer_store_dword v75, v74, s[48:51], 0 offen sc1
    s_mov_b64 exec, -1
L_noepoch:
    v_lshrrev_b32 v67, 5, v64
    v_and_b32 v68, 31, v64
    v_lshrrev_b32 v69, 2, v66
    v_and_b32 v71, 1, v65
    v_lshlrev_b32 v248, 4, v64
    s_mul_i32 s70, s52, 4160
    s_add_u32 s71, s70, 16640
    s_add_u32 s76, s70, 149760
    s_lshl_b32 s62, s52, 10
    v_add_u32 v238, s62, v248
    v_add_u32 v239, 3040, v238
    v_add_u32 v236, 6112, v238
    v_add_u32 v237, 9152, v238
    v_and_b32 v72, 3, v66
    v_mul_u32_u24 v232, 4160, v72
    v_bfe_u32 v73, v66, 2, 1
    v_mul_u32_u24 v73, 1056, v73
    v_add_u32 v232, v232, v73
    v_lshrrev_b32 v73, 3, v66
    v_lshl_add_u32 v232, v73, 8, v232
    v_lshl_add_u32 v232, v65, 4, v232
    v_add_u32 v232, 2080, v232
    v_mul_u32_u24 v233, 4160, v69
    v_mul_u32_u24 v73, 1056, v71
    v_add_u32 v233, v233, v73
    v_lshl_add_u32 v233, v67, 8, v233
    v_lshl_add_u32 v233, v72, 3, v233
    s_mul_i32 s75, s52, 15360
    s_add_u32 s75, s75, 102400
    v_add_u32 v111, s75, v248
    s_and_b32 s62, s52, 1
    s_lshl_b32 s62, s62, 2
    v_lshl_add_u32 v72, v65, 3, v69
    v_lshlrev_b32 v120, 8, v72
    v_lshl_add_u32 v73, v69, 1, v71
    v_xor_b32 v73, s62, v73
    v_lshl_add_u32 v120, v73, 5, v120
    v_and_b32 v73, 3, v64
    v_lshl_add_u32 v120, v73, 3, v120
    v_add_u32 v120, 32768, v120
    v_xor_b32 v121, 32, v120
    v_xor_b32 v122, 64, v120
    v_xor_b32 v123, 96, v120
    s_lshr_b32 s62, s52, 1
    s_lshl_b32 s62, s62, 13
    s_add_u32 s62, s62, 98304
    v_lshrrev_b32 v72, 1, v66
    v_xor_b32 v72, v72, v65
    v_lshlrev_b32 v72, 4, v72
    v_lshl_add_u32 v72, v66, 7, v72
    v_add_u32 v124, s62, v72
    v_xor_b32 v125, 64, v124
    s_lshl_b32 s62, s55, 21
    s_lshl_b32 s63, s56, 8
    s_add_u32 s62, s62, s63
    s_lshl_b32 s63, s52, 6
    s_add_u32 s62, s62, s63
    v_lshrrev_b32 v72, 2, v64
    v_and_b32 v73, 3, v64
    v_lshlrev_b32 v73, 4, v73
    v_lshl_add_u32 v109, v72, 11, v73
    v_add_u32 v109, s62, v109
    s_lshl_b32 s17, s53, 18
    s_sub_u32 s62, s62, s63
    s_lshl_b32 s63, s52, 16
    s_add_u32 s62, s62, s63
    s_add_u32 s62, s62, s17
    v_lshlrev_b32 v73, 4, v66
    v_lshl_add_u32 v249, v65, 11, v73
    v_add_u32 v249, s62, v249
    v_xor_b32 v133, 256, v249
    v_lshlrev_b32 v72, 4, v66
    v_lshl_add_u32 v72, v67, 8, v72
    v_lshl_add_u32 v128, v71, 9, v72
    v_lshlrev_b32 v72, 4, v65
    v_lshl_add_u32 v110, v66, 11, v72
    s_mov_b32 s67, 0
    s_lshr_b32 s18, s57, 2
    s_lshl_b32 s18, s18, 4
    s_lshl_b32 s63, s55, 2
    s_add_u32 s18, s18, s63
    s_add_u32 s18, s18, s52
    s_lshl_b32 s18, s18, 7
    s_add_u32 s18, s18, 0x2000000
    s_lshl_b32 s8, s57, 5
    s_lshl_b32 s63, s55, 3
    s_add_u32 s8, s8, s63
    s_lshl_b32 s63, s52, 1
    s_add_u32 s8, s8, s63
    s_lshl_b32 s8, s8, 12
    s_cmp_eq_u32 s58, 1
    s_cbranch_scc1 L_role_a
    s_add_u32 m0, s7, 49152
    s_or_b32 s6, s4, 0
    buffer_load_dwordx4 v112, s[32:35], s6 offen offset:0 lds
    s_add_u32 s4, s4, 524288
    s_and_b32 s4, s4, 1572864
    buffer_load_dwordx4 v113, s[32:35], s6 offen offset:1024 lds
    buffer_load_dwordx4 v114, s[32:35], s6 offen offset:2048 lds
    buffer_load_dwordx4 v115, s[32:35], s6 offen offset:3072 lds
    s_add_u32 m0, s7, 114688
    s_lshr_b32 s6, s6, 12
    buffer_load_dwordx4 v116, s[20:23], s6 offen offset:0 lds
    buffer_load_dwordx4 v117, s[20:23], s6 offen offset:1024 lds
    buffer_load_dwordx4 v118, s[20:23], s6 offen offset:2048 lds
    buffer_load_dwordx4 v119, s[20:23], s6 offen offset:3072 lds
    s_waitcnt vmcnt(8)
    s_barrier
    ds_read_b64_tr_b16 v[144:145], v120 offset:0
    ds_read_b64_tr_b16 v[146:147], v120 offset:1024
    ds_read_b128 v[160:163], v124 offset:0
    ds_read_b64_tr_b16 v[148:149], v121 offset:0
    ds_read_b64_tr_b16 v[150:151], v121 offset:1024
    ds_read_b128 v[164:167], v124 offset:2048
    ds_read_b64_tr_b16 v[152:153], v122 offset:0
    ds_read_b64_tr_b16 v[154:155], v122 offset:1024
    ds_read_b64_tr_b16 v[156:157], v123 offset:0
    ds_read_b64_tr_b16 v[158:159], v123 offset:1024
    ds_read_b128 v[168:171], v124 offset:4096
    ds_read_b128 v[172:175], v124 offset:6144
    s_waitcnt lgkmcnt(6)
    v_mfma_f32_16x16x32_bf16 v[0:3], v[144:147], v[160:163], 0
    s_add_u32 m0, s7, 65536
    ds_read_b64_tr_b16 v[176:177], v120 offset:8192
    v_mfma_f32_16x16x32_bf16 v[4:7], v[148:151], v[160:163], 0
    s_or_b32 s6, s4, 0
    ds_read_b64_tr_b16 v[178:179], v120 offset:9216
    buffer_load_dwordx4 v112, s[32:35], s6 offen offset:0 lds
    s_add_u32 s4, s4, 524288
    s_and_b32 s4, s4, 1572864
    v_mfma_f32_16x16x32_bf16 v[16:19], v[144:147], v[164:167], 0
    ds_read_b128 v[192:195], v125 offset:0
    v_mfma_f32_16x16x32_bf16 v[20:23], v[148:151], v[164:167], 0
    s_waitcnt lgkmcnt(0)
    ds_read_b64_tr_b16 v[180:181], v121 offset:8192
    buffer_load_dwordx4 v113, s[32:35], s6 offen offset:1024 lds
    v_mfma_f32_16x16x32_bf16 v[8:11], v[152:155], v[160:163], 0
    ds_read_b64_tr_b16 v[182:183], v121 offset:9216
    v_mfma_f32_16x16x32_bf16 v[12:15], v[156:159], v[160:163], 0
    ds_read_b128 v[196:199], v125 offset:2048
    buffer_load_dwordx4 v114, s[32:35], s6 offen offset:2048 lds
    v_mfma_f32_16x16x32_bf16 v[24:27], v[152:155], v[164:167], 0
    ds_read_b64_tr_b16 v[184:185], v122 offset:8192
    v_mfma_f32_16x16x32_bf16 v[28:31], v[156:159], v[164:167], 0
    s_waitcnt lgkmcnt(0)
    ds_read_b64_tr_b16 v[186:187], v122 offset:9216
    buffer_load_dwordx4 v115, s[32:35], s6 offen offset:3072 lds
    s_add_u32 m0, s7, 131072
    s_lshr_b32 s6, s6, 12
    v_mfma_f32_16x16x32_bf16 v[32:35], v[144:147], v[168:171], 0
    ds_read_b64_tr_b16 v[188:189], v123 offset:8192
    v_mfma_f32_16x16x32_bf16 v[36:39], v[148:151], v[168:171], 0
    ds_read_b64_tr_b16 v[190:191], v123 offset:9216
    buffer_load_dwordx4 v116, s[20:23], s6 offen offset:0 lds
    v_mfma_f32_16x16x32_bf16 v[40:43], v[152:155], v[168:171], 0
    ds_read_b128 v[200:203], v125 offset:4096
    v_mfma_f32_16x16x32_bf16 v[44:47], v[156:159], v[168:171], 0
    ds_read_b128 v[204:207], v125 offset:6144
    buffer_load_dwordx4 v117, s[20:23], s6 offen offset:1024 lds
    v_mfma_f32_16x16x32_bf16 v[48:51], v[144:147], v[172:175], 0
    v_mfma_f32_16x16x32_bf16 v[52:55], v[148:151], v[172:175], 0
    buffer_load_dwordx4 v118, s[20:23], s6 offen offset:2048 lds
    v_mfma_f32_16x16x32_bf16 v[56:59], v[152:155], v[172:175], 0
    v_mfma_f32_16x16x32_bf16 v[60:63], v[156:159], v[172:175], 0
    s_waitcnt lgkmcnt(0)
    buffer_load_dwordx4 v119, s[20:23], s6 offen offset:3072 lds
    v_mfma_f32_16x16x32_bf16 v[0:3], v[176:179], v[192:195], v[0:3]
    s_waitcnt vmcnt(8)
    s_barrier
    ds_read_b64_tr_b16 v[144:145], v120 offset:16384
    v_mfma_f32_16x16x32_bf16 v[4:7], v[180:183], v[192:195], v[4:7]
    s_add_u32 m0, s7, 81920
    ds_read_b64_tr_b16 v[146:147], v120 offset:17408
    v_mfma_f32_16x16x32_bf16 v[16:19], v[176:179], v[196:199], v[16:19]
    s_or_b32 s6, s4, 0
    ds_read_b128 v[160:163], v124 offset:16384
    v_mfma_f32_16x16x32_bf16 v[20:23], v[180:183], v[196:199], v[20:23]
    s_waitcnt lgkmcnt(0)
    buffer_load_dwordx4 v112, s[32:35], s6 offen offset:0 lds
    v_mfma_f32_16x16x32_bf16 v[8:11], v[184:187], v[192:195], v[8:11]
    s_add_u32 s4, s4, 524288
    ds_read_b64_tr_b16 v[148:149], v121 offset:16384
    v_mfma_f32_16x16x32_bf16 v[12:15], v[188:191], v[192:195], v[12:15]
    s_and_b32 s4, s4, 1572864
    ds_read_b64_tr_b16 v[150:151], v121 offset:17408
    v_mfma_f32_16x16x32_bf16 v[24:27], v[184:187], v[196:199], v[24:27]
    ds_read_b128 v[164:167], v124 offset:18432
    v_mfma_f32_16x16x32_bf16 v[28:31], v[188:191], v[196:199], v[28:31]
    s_waitcnt lgkmcnt(0)
    buffer_load_dwordx4 v113, s[32:35], s6 offen offset:1024 lds
    v_mfma_f32_16x16x32_bf16 v[32:35], v[176:179], v[200:203], v[32:35]
    ds_read_b64_tr_b16 v[152:153], v122 offset:16384
    v_mfma_f32_16x16x32_bf16 v[36:39], v[180:183], v[200:203], v[36:39]
    ds_read_b64_tr_b16 v[154:155], v122 offset:17408
    v_mfma_f32_16x16x32_bf16 v[40:43], v[184:187], v[200:203], v[40:43]
    ds_read_b64_tr_b16 v[156:157], v123 offset:16384
    v_mfma_f32_16x16x32_bf16 v[44:47], v[188:191], v[200:203], v[44:47]
    buffer_load_dwordx4 v114, s[32:35], s6 offen offset:2048 lds
    v_mfma_f32_16x16x32_bf16 v[48:51], v[176:179], v[204:207], v[48:51]
    ds_read_b64_tr_b16 v[158:159], v123 offset:17408
    v_mfma_f32_16x16x32_bf16 v[52:55], v[180:183], v[204:207], v[52:55]
    ds_read_b128 v[168:171], v124 offset:20480
    v_mfma_f32_16x16x32_bf16 v[56:59], v[184:187], v[204:207], v[56:59]
    ds_read_b128 v[172:175], v124 offset:22528
    v_mfma_f32_16x16x32_bf16 v[60:63], v[188:191], v[204:207], v[60:63]
    s_waitcnt lgkmcnt(0)
    buffer_load_dwordx4 v115, s[32:35], s6 offen offset:3072 lds
    v_mfma_f32_16x16x32_bf16 v[0:3], v[144:147], v[160:163], v[0:3]
    s_add_u32 m0, s7, 147456
    ds_read_b64_tr_b16 v[176:177], v120 offset:24576
    v_mfma_f32_16x16x32_bf16 v[4:7], v[148:151], v[160:163], v[4:7]
    s_lshr_b32 s6, s6, 12
    ds_read_b64_tr_b16 v[178:179], v120 offset:25600
    v_mfma_f32_16x16x32_bf16 v[16:19], v[144:147], v[164:167], v[16:19]
    ds_read_b128 v[192:195], v125 offset:16384
    v_mfma_f32_16x16x32_bf16 v[20:23], v[148:151], v[164:167], v[20:23]
    s_waitcnt lgkmcnt(0)
    buffer_load_dwordx4 v116, s[20:23], s6 offen offset:0 lds
    v_mfma_f32_16x16x32_bf16 v[8:11], v[152:155], v[160:163], v[8:11]
    ds_read_b64_tr_b16 v[180:181], v121 offset:24576
    v_mfma_f32_16x16x32_bf16 v[12:15], v[156:159], v[160:163], v[12:15]
    ds_read_b64_tr_b16 v[182:183], v121 offset:25600
    v_mfma_f32_16x16x32_bf16 v[24:27], v[152:155], v[164:167], v[24:27]
    ds_read_b128 v[196:199], v125 offset:18432
    v_mfma_f32_16x16x32_bf16 v[28:31], v[156:159], v[164:167], v[28:31]
    s_waitcnt lgkmcnt(0)
    buffer_load_dwordx4 v117, s[20:23], s6 offen offset:1024 lds
    v_mfma_f32_16x16x32_bf16 v[32:35], v[144:147], v[168:171], v[32:35]
    ds_read_b64_tr_b16 v[184:185], v122 offset:24576
    v_mfma_f32_16x16x32_bf16 v[36:39], v[148:151], v[168:171], v[36:39]
    ds_read_b64_tr_b16 v[186:187], v122 offset:25600
    v_mfma_f32_16x16x32_bf16 v[40:43], v[152:155], v[168:171], v[40:43]
    ds_read_b64_tr_b16 v[188:189], v123 offset:24576
    v_mfma_f32_16x16x32_bf16 v[44:47], v[156:159], v[168:171], v[44:47]
    buffer_load_dwordx4 v118, s[20:23], s6 offen offset:2048 lds
    v_mfma_f32_16x16x32_bf16 v[48:51], v[144:147], v[172:175], v[48:51]
    ds_read_b64_tr_b16 v[190:191], v123 offset:25600
    v_mfma_f32_16x16x32_bf16 v[52:55], v[148:151], v[172:175], v[52:55]
    ds_read_b128 v[200:203], v125 offset:20480
    v_mfma_f32_16x16x32_bf16 v[56:59], v[152:155], v[172:175], v[56:59]
    ds_read_b128 v[204:207], v125 offset:22528
    v_mfma_f32_16x16x32_bf16 v[60:63], v[156:159], v[172:175], v[60:63]
    s_waitcnt lgkmcnt(0)
    buffer_load_dwordx4 v119, s[20:23], s6 offen offset:3072 lds
    v_mfma_f32_16x16x32_bf16 v[0:3], v[176:179], v[192:195], v[0:3]
    s_waitcnt vmcnt(8)
    s_barrier
    ds_read_b64_tr_b16 v[144:145], v120 offset:32768
    v_mfma_f32_16x16x32_bf16 v[4:7], v[180:183], v[192:195], v[4:7]
    s_add_u32 m0, s7, 32768
    ds_read_b64_tr_b16 v[146:147], v120 offset:33792
    v_mfma_f32_16x16x32_bf16 v[16:19], v[176:179], v[196:199], v[16:19]
    s_or_b32 s6, s4, 2097152
    ds_read_b128 v[160:163], v124 offset:32768
    v_mfma_f32_16x16x32_bf16 v[20:23], v[180:183], v[196:199], v[20:23]
    s_waitcnt lgkmcnt(0)
    buffer_load_dwordx4 v112, s[32:35], s6 offen offset:0 lds
    v_mfma_f32_16x16x32_bf16 v[8:11], v[184:187], v[192:195], v[8:11]
    s_add_u32 s4, s4, 524288
    ds_read_b64_tr_b16 v[148:149], v121 offset:32768
    v_mfma_f32_16x16x32_bf16 v[12:15], v[188:191], v[192:195], v[12:15]
    s_and_b32 s4, s4, 1572864
    ds_read_b64_tr_b16 v[150:151], v121 offset:33792
    v_mfma_f32_16x16x32_bf16 v[24:27], v[184:187], v[196:199], v[24:27]
    ds_read_b128 v[164:167], v124 offset:34816
    v_mfma_f32_16x16x32_bf16 v[28:31], v[188:191], v[196:199], v[28:31]
    s_waitcnt lgkmcnt(0)
    buffer_load_dwordx4 v113, s[32:35], s6 offen offset:1024 lds
    v_mfma_f32_16x16x32_bf16 v[32:35], v[176:179], v[200:203], v[32:35]
    ds_read_b64_tr_b16 v[152:153], v122 offset:32768
    v_mfma_f32_16x16x32_bf16 v[36:39], v[180:183], v[200:203], v[36:39]
    ds_read_b64_tr_b16 v[154:155], v122 offset:33792
    v_mfma_f32_16x16x32_bf16 v[40:43], v[184:187], v[200:203], v[40:43]
    ds_read_b64_tr_b16 v[156:157], v123 offset:32768
    v_mfma_f32_16x16x32_bf16 v[44:47], v[188:191], v[200:203], v[44:47]
    buffer_load_dwordx4 v114, s[32:35], s6 offen offset:2048 lds
    v_mfma_f32_16x16x32_bf16 v[48:51], v[176:179], v[204:207], v[48:51]
    ds_read_b64_tr_b16 v[158:159], v123 offset:33792
    v_mfma_f32_16x16x32_bf16 v[52:55], v[180:183], v[204:207], v[52:55]
    ds_read_b128 v[168:171], v124 offset:36864
    v_mfma_f32_16x16x32_bf16 v[56:59], v[184:187], v[204:207], v[56:59]
    ds_read_b128 v[172:175], v124 offset:38912
    v_mfma_f32_16x16x32_bf16 v[60:63], v[188:191], v[204:207], v[60:63]
    s_waitcnt lgkmcnt(0)
    buffer_load_dwordx4 v115, s[32:35], s6 offen offset:3072 lds
    v_mfma_f32_16x16x32_bf16 v[0:3], v[144:147], v[160:163], v[0:3]
    s_add_u32 m0, s7, 98304
    ds_read_b64_tr_b16 v[176:177], v120 offset:40960
    v_mfma_f32_16x16x32_bf16 v[4:7], v[148:151], v[160:163], v[4:7]
    s_lshr_b32 s6, s6, 12
    ds_read_b64_tr_b16 v[178:179], v120 offset:41984
    v_mfma_f32_16x16x32_bf16 v[16:19], v[144:147], v[164:167], v[16:19]
    ds_read_b128 v[192:195], v125 offset:32768
    v_mfma_f32_16x16x32_bf16 v[20:23], v[148:151], v[164:167], v[20:23]
    s_waitcnt lgkmcnt(0)
    buffer_load_dwordx4 v116, s[20:23], s6 offen offset:0 lds
    v_mfma_f32_16x16x32_bf16 v[8:11], v[152:155], v[160:163], v[8:11]
    ds_read_b64_tr_b16 v[180:181], v121 offset:40960
    v_mfma_f32_16x16x32_bf16 v[12:15], v[156:159], v[160:163], v[12:15]
    ds_read_b64_tr_b16 v[182:183], v121 offset:41984
    v_mfma_f32_16x16x32_bf16 v[24:27], v[152:155], v[164:167], v[24:27]
    ds_read_b128 v[196:199], v125 offset:34816
    v_mfma_f32_16x16x32_bf16 v[28:31], v[156:159], v[164:167], v[28:31]
    s_waitcnt lgkmcnt(0)
    buffer_load_dwordx4 v117, s[20:23], s6 offen offset:1024 lds
    v_mfma_f32_16x16x32_bf16 v[32:35], v[144:147], v[168:171], v[32:35]
    ds_read_b64_tr_b16 v[184:185], v122 offset:40960
    v_mfma_f32_16x16x32_bf16 v[36:39], v[148:151], v[168:171], v[36:39]
    ds_read_b64_tr_b16 v[186:187], v122 offset:41984
    v_mfma_f32_16x16x32_bf16 v[40:43], v[152:155], v[168:171], v[40:43]
    ds_read_b64_tr_b16 v[188:189], v123 offset:40960
    v_mfma_f32_16x16x32_bf16 v[44:47], v[156:159], v[168:171], v[44:47]
    buffer_load_dwordx4 v118, s[20:23], s6 offen offset:2048 lds
    v_mfma_f32_16x16x32_bf16 v[48:51], v[144:147], v[172:175], v[48:51]
    ds_read_b64_tr_b16 v[190:191], v123 offset:41984
    v_mfma_f32_16x16x32_bf16 v[52:55], v[148:151], v[172:175], v[52:55]
    ds_read_b128 v[200:203], v125 offset:36864
    v_mfma_f32_16x16x32_bf16 v[56:59], v[152:155], v[172:175], v[56:59]
    ds_read_b128 v[204:207], v125 offset:38912
    v_mfma_f32_16x16x32_bf16 v[60:63], v[156:159], v[172:175], v[60:63]
    s_waitcnt lgkmcnt(0)
    buffer_load_dwordx4 v119, s[20:23], s6 offen offset:3072 lds
    v_mfma_f32_16x16x32_bf16 v[0:3], v[176:179], v[192:195], v[0:3]
    s_waitcnt vmcnt(8)
    s_barrier
    ds_read_b64_tr_b16 v[144:145], v120 offset:49152
    v_mfma_f32_16x16x32_bf16 v[4:7], v[180:183], v[192:195], v[4:7]
    s_add_u32 m0, s7, 49152
    ds_read_b64_tr_b16 v[146:147], v120 offset:50176
    v_mfma_f32_16x16x32_bf16 v[16:19], v[176:179], v[196:199], v[16:19]
    s_or_b32 s6, s4, 2097152
    ds_read_b128 v[160:163], v124 offset:49152
    v_mfma_f32_16x16x32_bf16 v[20:23], v[180:183], v[196:199], v[20:23]
    s_waitcnt lgkmcnt(0)
    buffer_load_dwordx4 v112, s[32:35], s6 offen offset:0 lds
    v_mfma_f32_16x16x32_bf16 v[8:11], v[184:187], v[192:195], v[8:11]
    s_add_u32 s4, s4, 524288
    ds_read_b64_tr_b16 v[148:149], v121 offset:49152
    v_mfma_f32_16x16x32_bf16 v[12:15], v[188:191], v[192:195], v[12:15]
    s_and_b32 s4, s4, 1572864
    ds_read_b64_tr_b16 v[150:151], v121 offset:50176
    v_mfma_f32_16x16x32_bf16 v[24:27], v[184:187], v[196:199], v[24:27]
    ds_read_b128 v[164:167], v124 offset:51200
    v_mfma_f32_16x16x32_bf16 v[28:31], v[188:191], v[196:199], v[28:31]
    s_waitcnt lgkmcnt(0)
    buffer_load_dwordx4 v113, s[32:35], s6 offen offset:1024 lds
    v_mfma_f32_16x16x32_bf16 v[32:35], v[176:179], v[200:203], v[32:35]
    ds_read_b64_tr_b16 v[152:153], v122 offset:49152
    v_mfma_f32_16x16x32_bf16 v[36:39], v[180:183], v[200:203], v[36:39]
    ds_read_b64_tr_b16 v[154:155], v122 offset:50176
    v_mfma_f32_16x16x32_bf16 v[40:43], v[184:187], v[200:203], v[40:43]
    ds_read_b64_tr_b16 v[156:157], v123 offset:49152
    v_mfma_f32_16x16x32_bf16 v[44:47], v[188:191], v[200:203], v[44:47]
    buffer_load_dwordx4 v114, s[32:35], s6 offen offset:2048 lds
    v_mfma_f32_16x16x32_bf16 v[48:51], v[176:179], v[204:207], v[48:51]
    ds_read_b64_tr_b16 v[158:159], v123 offset:50176
    v_mfma_f32_16x16x32_bf16 v[52:55], v[180:183], v[204:207], v[52:55]
    ds_read_b128 v[168:171], v124 offset:53248
    v_mfma_f32_16x16x32_bf16 v[56:59], v[184:187], v[204:207], v[56:59]
    ds_read_b128 v[172:175], v124 offset:55296
    v_mfma_f32_16x16x32_bf16 v[60:63], v[188:191], v[204:207], v[60:63]
    s_waitcnt lgkmcnt(0)
    buffer_load_dwordx4 v115, s[32:35], s6 offen offset:3072 lds
    v_mfma_f32_16x16x32_bf16 v[0:3], v[144:147], v[160:163], v[0:3]
    s_add_u32 m0, s7, 114688
    ds_read_b64_tr_b16 v[176:177], v120 offset:57344
    v_mfma_f32_16x16x32_bf16 v[4:7], v[148:151], v[160:163], v[4:7]
    s_lshr_b32 s6, s6, 12
    ds_read_b64_tr_b16 v[178:179], v120 offset:58368
    v_mfma_f32_16x16x32_bf16 v[16:19], v[144:147], v[164:167], v[16:19]
    ds_read_b128 v[192:195], v125 offset:49152
    v_mfma_f32_16x16x32_bf16 v[20:23], v[148:151], v[164:167], v[20:23]
    s_waitcnt lgkmcnt(0)
    buffer_load_dwordx4 v116, s[20:23], s6 offen offset:0 lds
    v_mfma_f32_16x16x32_bf16 v[8:11], v[152:155], v[160:163], v[8:11]
    ds_read_b64_tr_b16 v[180:181], v121 offset:57344
    v_mfma_f32_16x16x32_bf16 v[12:15], v[156:159], v[160:163], v[12:15]
    ds_read_b64_tr_b16 v[182:183], v121 offset:58368
    v_mfma_f32_16x16x32_bf16 v[24:27], v[152:155], v[164:167], v[24:27]
    ds_read_b128 v[196:199], v125 offset:51200
    v_mfma_f32_16x16x32_bf16 v[28:31], v[156:159], v[164:167], v[28:31]
    s_waitcnt lgkmcnt(0)
    buffer_load_dwordx4 v117, s[20:23], s6 offen offset:1024 lds
    v_mfma_f32_16x16x32_bf16 v[32:35], v[144:147], v[168:171], v[32:35]
    ds_read_b64_tr_b16 v[184:185], v122 offset:57344
    v_mfma_f32_16x16x32_bf16 v[36:39], v[148:151], v[168:171], v[36:39]
    ds_read_b64_tr_b16 v[186:187], v122 offset:58368
    v_mfma_f32_16x16x32_bf16 v[40:43], v[152:155], v[168:171], v[40:43]
    ds_read_b64_tr_b16 v[188:189], v123 offset:57344
    v_mfma_f32_16x16x32_bf16 v[44:47], v[156:159], v[168:171], v[44:47]
    buffer_load_dwordx4 v118, s[20:23], s6 offen offset:2048 lds
    v_mfma_f32_16x16x32_bf16 v[48:51], v[144:147], v[172:175], v[48:51]
    ds_read_b64_tr_b16 v[190:191], v123 offset:58368
    v_mfma_f32_16x16x32_bf16 v[52:55], v[148:151], v[172:175], v[52:55]
    ds_read_b128 v[200:203], v125 offset:53248
    v_mfma_f32_16x16x32_bf16 v[56:59], v[152:155], v[172:175], v[56:59]
    ds_read_b128 v[204:207], v125 offset:55296
    v_mfma_f32_16x16x32_bf16 v[60:63], v[156:159], v[172:175], v[60:63]
    s_waitcnt lgkmcnt(0)
    buffer_load_dwordx4 v119, s[20:23], s6 offen offset:3072 lds
    v_mfma_f32_16x16x32_bf16 v[0:3], v[176:179], v[192:195], v[0:3]
    s_waitcnt vmcnt(8)
    s_barrier
    ds_read_b64_tr_b16 v[144:145], v120 offset:0
    v_mfma_f32_16x16x32_bf16 v[4:7], v[180:183], v[192:195], v[4:7]
    s_add_u32 m0, s7, 65536
    ds_read_b64_tr_b16 v[146:147], v120 offset:1024
    v_mfma_f32_16x16x32_bf16 v[16:19], v[176:179], v[196:199], v[16:19]
    s_or_b32 s6, s4, 2097152
    ds_read_b128 v[160:163], v124 offset:0
    v_mfma_f32_16x16x32_bf16 v[20:23], v[180:183], v[196:199], v[20:23]
    s_waitcnt lgkmcnt(0)
    buffer_load_dwordx4 v112, s[32:35], s6 offen offset:0 lds
    v_mfma_f32_16x16x32_bf16 v[8:11], v[184:187], v[192:195], v[8:11]
    s_add_u32 s4, s4, 524288
    ds_read_b64_tr_b16 v[148:149], v121 offset:0
    v_mfma_f32_16x16x32_bf16 v[12:15], v[188:191], v[192:195], v[12:15]
    s_and_b32 s4, s4, 1572864
    ds_read_b64_tr_b16 v[150:151], v121 offset:1024
    v_mfma_f32_16x16x32_bf16 v[24:27], v[184:187], v[196:199], v[24:27]
    ds_read_b128 v[164:167], v124 offset:2048
    v_mfma_f32_16x16x32_bf16 v[28:31], v[188:191], v[196:199], v[28:31]
    s_waitcnt lgkmcnt(0)
    buffer_load_dwordx4 v113, s[32:35], s6 offen offset:1024 lds
    v_mfma_f32_16x16x32_bf16 v[32:35], v[176:179], v[200:203], v[32:35]
    ds_read_b64_tr_b16 v[152:153], v122 offset:0
    v_mfma_f32_16x16x32_bf16 v[36:39], v[180:183], v[200:203], v[36:39]
    ds_read_b64_tr_b16 v[154:155], v122 offset:1024
    v_mfma_f32_16x16x32_bf16 v[40:43], v[184:187], v[200:203], v[40:43]
    ds_read_b64_tr_b16 v[156:157], v123 offset:0
    v_mfma_f32_16x16x32_bf16 v[44:47], v[188:191], v[200:203], v[44:47]
    buffer_load_dwordx4 v114, s[32:35], s6 offen offset:2048 lds
    v_mfma_f32_16x16x32_bf16 v[48:51], v[176:179], v[204:207], v[48:51]
    ds_read_b64_tr_b16 v[158:159], v123 offset:1024
    v_mfma_f32_16x16x32_bf16 v[52:55], v[180:183], v[204:207], v[52:55]
    ds_read_b128 v[168:171], v124 offset:4096
    v_mfma_f32_16x16x32_bf16 v[56:59], v[184:187], v[204:207], v[56:59]
    ds_read_b128 v[172:175], v124 offset:6144
    v_mfma_f32_16x16x32_bf16 v[60:63], v[188:191], v[204:207], v[60:63]
    s_waitcnt lgkmcnt(0)
    buffer_load_dwordx4 v115, s[32:35], s6 offen offset:3072 lds
    v_mfma_f32_16x16x32_bf16 v[0:3], v[144:147], v[160:163], v[0:3]
    s_add_u32 m0, s7, 131072
    ds_read_b64_tr_b16 v[176:177], v120 offset:8192
    v_mfma_f32_16x16x32_bf16 v[4:7], v[148:151], v[160:163], v[4:7]
    s_lshr_b32 s6, s6, 12
    ds_read_b64_tr_b16 v[178:179], v120 offset:9216
    v_mfma_f32_16x16x32_bf16 v[16:19], v[144:147], v[164:167], v[16:19]
    ds_read_b128 v[192:195], v125 offset:0
    v_mfma_f32_16x16x32_bf16 v[20:23], v[148:151], v[164:167], v[20:23]
    s_waitcnt lgkmcnt(0)
    buffer_load_dwordx4 v116, s[20:23], s6 offen offset:0 lds
    v_mfma_f32_16x16x32_bf16 v[8:11], v[152:155], v[160:163], v[8:11]
    ds_read_b64_tr_b16 v[180:181], v121 offset:8192
    v_mfma_f32_16x16x32_bf16 v[12:15], v[156:159], v[160:163], v[12:15]
    ds_read_b64_tr_b16 v[182:183], v121 offset:9216
    v_mfma_f32_16x16x32_bf16 v[24:27], v[152:155], v[164:167], v[24:27]
    ds_read_b128 v[196:199], v125 offset:2048
    v_mfma_f32_16x16x32_bf16 v[28:31], v[156:159], v[164:167], v[28:31]
    s_waitcnt lgkmcnt(0)
    buffer_load_dwordx4 v117, s[20:23], s6 offen offset:1024 lds
    v_mfma_f32_16x16x32_bf16 v[32:35], v[144:147], v[168:171], v[32:35]
    ds_read_b64_tr_b16 v[184:185], v122 offset:8192
    v_mfma_f32_16x16x32_bf16 v[36:39], v[148:151], v[168:171], v[36:39]
    ds_read_b64_tr_b16 v[186:187], v122 offset:9216
    v_mfma_f32_16x16x32_bf16 v[40:43], v[152:155], v[168:171], v[40:43]
    ds_read_b64_tr_b16 v[188:189], v123 offset:8192
    v_mfma_f32_16x16x32_bf16 v[44:47], v[156:159], v[168:171], v[44:47]
    buffer_load_dwordx4 v118, s[20:23], s6 offen offset:2048 lds
    v_mfma_f32_16x16x32_bf16 v[48:51], v[144:147], v[172:175], v[48:51]
    ds_read_b64_tr_b16 v[190:191], v123 offset:9216
    v_mfma_f32_16x16x32_bf16 v[52:55], v[148:151], v[172:175], v[52:55]
    ds_read_b128 v[200:203], v125 offset:4096
    v_mfma_f32_16x16x32_bf16 v[56:59], v[152:155], v[172:175], v[56:59]
    ds_read_b128 v[204:207], v125 offset:6144
    v_mfma_f32_16x16x32_bf16 v[60:63], v[156:159], v[172:175], v[60:63]
    s_waitcnt lgkmcnt(0)
    buffer_load_dwordx4 v119, s[20:23], s6 offen offset:3072 lds
    v_mfma_f32_16x16x32_bf16 v[0:3], v[176:179], v[192:195], v[0:3]
    s_waitcnt vmcnt(8)
    s_barrier
    ds_read_b64_tr_b16 v[144:145], v120 offset:16384
    v_mfma_f32_16x16x32_bf16 v[4:7], v[180:183], v[192:195], v[4:7]
    s_add_u32 m0, s7, 81920
    ds_read_b64_tr_b16 v[146:147], v120 offset:17408
    v_mfma_f32_16x16x32_bf16 v[16:19], v[176:179], v[196:199], v[16:19]
    s_or_b32 s6, s4, 2097152
    ds_read_b128 v[160:163], v124 offset:16384
    v_mfma_f32_16x16x32_bf16 v[20:23], v[180:183], v[196:199], v[20:23]
    s_waitcnt lgkmcnt(0)
    buffer_load_dwordx4 v112, s[32:35], s6 offen offset:0 lds
    v_mfma_f32_16x16x32_bf16 v[8:11], v[184:187], v[192:195], v[8:11]
    s_add_u32 s4, s4, 524288
    ds_read_b64_tr_b16 v[148:149], v121 offset:16384
    v_mfma_f32_16x16x32_bf16 v[12:15], v[188:191], v[192:195], v[12:15]
    s_and_b32 s4, s4, 1572864
    ds_read_b64_tr_b16 v[150:151], v121 offset:17408
    v_mfma_f32_16x16x32_bf16 v[24:27], v[184:187], v[196:199], v[24:27]
    ds_read_b128 v[164:167], v124 offset:18432
    v_mfma_f32_16x16x32_bf16 v[28:31], v[188:191], v[196:199], v[28:31]
    s_waitcnt lgkmcnt(0)
    buffer_load_dwordx4 v113, s[32:35], s6 offen offset:1024 lds
    v_mfma_f32_16x16x32_bf16 v[32:35], v[176:179], v[200:203], v[32:35]
    ds_read_b64_tr_b16 v[152:153], v122 offset:16384
    v_mfma_f32_16x16x32_bf16 v[36:39], v[180:183], v[200:203], v[36:39]
    ds_read_b64_tr_b16 v[154:155], v122 offset:17408
    v_mfma_f32_16x16x32_bf16 v[40:43], v[184:187], v[200:203], v[40:43]
    ds_read_b64_tr_b16 v[156:157], v123 offset:16384
    v_mfma_f32_16x16x32_bf16 v[44:47], v[188:191], v[200:203], v[44:47]
    buffer_load_dwordx4 v114, s[32:35], s6 offen offset:2048 lds
    v_mfma_f32_16x16x32_bf16 v[48:51], v[176:179], v[204:207], v[48:51]
    ds_read_b64_tr_b16 v[158:159], v123 offset:17408
    v_mfma_f32_16x16x32_bf16 v[52:55], v[180:183], v[204:207], v[52:55]
    ds_read_b128 v[168:171], v124 offset:20480
    v_mfma_f32_16x16x32_bf16 v[56:59], v[184:187], v[204:207], v[56:59]
    ds_read_b128 v[172:175], v124 offset:22528
    v_mfma_f32_16x16x32_bf16 v[60:63], v[188:191], v[204:207], v[60:63]
    s_waitcnt lgkmcnt(0)
    buffer_load_dwordx4 v115, s[32:35], s6 offen offset:3072 lds
    v_mfma_f32_16x16x32_bf16 v[0:3], v[144:147], v[160:163], v[0:3]
    s_add_u32 m0, s7, 147456
    ds_read_b64_tr_b16 v[176:177], v120 offset:24576
    v_mfma_f32_16x16x32_bf16 v[4:7], v[148:151], v[160:163], v[4:7]
    s_lshr_b32 s6, s6, 12
    ds_read_b64_tr_b16 v[178:179], v120 offset:25600
    v_mfma_f32_16x16x32_bf16 v[16:19], v[144:147], v[164:167], v[16:19]
    ds_read_b128 v[192:195], v125 offset:16384
    v_mfma_f32_16x16x32_bf16 v[20:23], v[148:151], v[164:167], v[20:23]
    s_waitcnt lgkmcnt(5)
    buffer_load_dwordx4 v116, s[20:23], s6 offen offset:0 lds
    v_mfma_f32_16x16x32_bf16 v[8:11], v[152:155], v[160:163], v[8:11]
    ds_read_b64_tr_b16 v[180:181], v121 offset:24576
    v_mfma_f32_16x16x32_bf16 v[12:15], v[156:159], v[160:163], v[12:15]
    ds_read_b64_tr_b16 v[182:183], v121 offset:25600
    v_mfma_f32_16x16x32_bf16 v[24:27], v[152:155], v[164:167], v[24:27]
    ds_read_b128 v[196:199], v125 offset:18432
    v_mfma_f32_16x16x32_bf16 v[28:31], v[156:159], v[164:167], v[28:31]
    s_waitcnt lgkmcnt(0)
    buffer_load_dwordx4 v117, s[20:23], s6 offen offset:1024 lds
    v_mfma_f32_16x16x32_bf16 v[32:35], v[144:147], v[168:171], v[32:35]
    ds_read_b64_tr_b16 v[184:185], v122 offset:24576
    v_mfma_f32_16x16x32_bf16 v[36:39], v[148:151], v[168:171], v[36:39]
    ds_read_b64_tr_b16 v[186:187], v122 offset:25600
    v_mfma_f32_16x16x32_bf16 v[40:43], v[152:155], v[168:171], v[40:43]
    ds_read_b64_tr_b16 v[188:189], v123 offset:24576
    v_mfma_f32_16x16x32_bf16 v[44:47], v[156:159], v[168:171], v[44:47]
    buffer_load_dwordx4 v118, s[20:23], s6 offen offset:2048 lds
    v_mfma_f32_16x16x32_bf16 v[48:51], v[144:147], v[172:175], v[48:51]
    ds_read_b64_tr_b16 v[190:191], v123 offset:25600
    v_mfma_f32_16x16x32_bf16 v[52:55], v[148:151], v[172:175], v[52:55]
    ds_read_b128 v[200:203], v125 offset:20480
    v_mfma_f32_16x16x32_bf16 v[56:59], v[152:155], v[172:175], v[56:59]
    ds_read_b128 v[204:207], v125 offset:22528
    v_mfma_f32_16x16x32_bf16 v[60:63], v[156:159], v[172:175], v[60:63]
    s_waitcnt lgkmcnt(0)
    buffer_load_dwordx4 v119, s[20:23], s6 offen offset:3072 lds
    v_mfma_f32_16x16x32_bf16 v[0:3], v[176:179], v[192:195], v[0:3]
    s_waitcnt vmcnt(8)
    s_barrier
    ds_read_b64_tr_b16 v[144:145], v120 offset:32768
    v_mfma_f32_16x16x32_bf16 v[4:7], v[180:183], v[192:195], v[4:7]
    s_add_u32 m0, s7, 32768
    ds_read_b64_tr_b16 v[146:147], v120 offset:33792
    v_mfma_f32_16x16x32_bf16 v[16:19], v[176:179], v[196:199], v[16:19]
    s_or_b32 s6, s4, 4194304
    ds_read_b128 v[160:163], v124 offset:32768
    v_mfma_f32_16x16x32_bf16 v[20:23], v[180:183], v[196:199], v[20:23]
    s_waitcnt lgkmcnt(5)
    buffer_load_dwordx4 v112, s[32:35], s6 offen offset:0 lds
    v_mfma_f32_16x16x32_bf16 v[8:11], v[184:187], v[192:195], v[8:11]
    s_add_u32 s4, s4, 524288
    ds_read_b64_tr_b16 v[148:149], v121 offset:32768
    v_mfma_f32_16x16x32_bf16 v[12:15], v[188:191], v[192:195], v[12:15]
    s_and_b32 s4, s4, 1572864
    ds_read_b64_tr_b16 v[150:151], v121 offset:33792
    v_mfma_f32_16x16x32_bf16 v[24:27], v[184:187], v[196:199], v[24:27]
    ds_read_b128 v[164:167], v124 offset:34816
    v_mfma_f32_16x16x32_bf16 v[28:31], v[188:191], v[196:199], v[28:31]
    s_waitcnt lgkmcnt(0)
    buffer_load_dwordx4 v113, s[32:35], s6 offen offset:1024 lds
    v_mfma_f32_16x16x32_bf16 v[32:35], v[176:179], v[200:203], v[32:35]
    ds_read_b64_tr_b16 v[152:153], v122 offset:32768
    v_mfma_f32_16x16x32_bf16 v[36:39], v[180:183], v[200:203], v[36:39]
    ds_read_b64_tr_b16 v[154:155], v122 offset:33792
    v_mfma_f32_16x16x32_bf16 v[40:43], v[184:187], v[200:203], v[40:43]
    ds_read_b64_tr_b16 v[156:157], v123 offset:32768
    v_mfma_f32_16x16x32_bf16 v[44:47], v[188:191], v[200:203], v[44:47]
    buffer_load_dwordx4 v114, s[32:35], s6 offen offset:2048 lds
    v_mfma_f32_16x16x32_bf16 v[48:51], v[176:179], v[204:207], v[48:51]
    ds_read_b64_tr_b16 v[158:159], v123 offset:33792
    v_mfma_f32_16x16x32_bf16 v[52:55], v[180:183], v[204:207], v[52:55]
    ds_read_b128 v[168:171], v124 offset:36864
    v_mfma_f32_16x16x32_bf16 v[56:59], v[184:187], v[204:207], v[56:59]
    ds_read_b128 v[172:175], v124 offset:38912
    v_mfma_f32_16x16x32_bf16 v[60:63], v[188:191], v[204:207], v[60:63]
    s_waitcnt lgkmcnt(0)
    buffer_load_dwordx4 v115, s[32:35], s6 offen offset:3072 lds
    v_mfma_f32_16x16x32_bf16 v[0:3], v[144:147], v[160:163], v[0:3]
    s_add_u32 m0, s7, 98304
    ds_read_b64_tr_b16 v[176:177], v120 offset:40960
    v_mfma_f32_16x16x32_bf16 v[4:7], v[148:151], v[160:163], v[4:7]
    s_lshr_b32 s6, s6, 12
    ds_read_b64_tr_b16 v[178:179], v120 offset:41984
    v_mfma_f32_16x16x32_bf16 v[16:19], v[144:147], v[164:167], v[16:19]
    ds_read_b128 v[192:195], v125 offset:32768
    v_mfma_f32_16x16x32_bf16 v[20:23], v[148:151], v[164:167], v[20:23]
    s_waitcnt lgkmcnt(5)
    buffer_load_dwordx4 v116, s[20:23], s6 offen offset:0 lds
    v_mfma_f32_16x16x32_bf16 v[8:11], v[152:155], v[160:163], v[8:11]
    ds_read_b64_tr_b16 v[180:181], v121 offset:40960
    v_mfma_f32_16x16x32_bf16 v[12:15], v[156:159], v[160:163], v[12:15]
    ds_read_b64_tr_b16 v[182:183], v121 offset:41984
    v_mfma_f32_16x16x32_bf16 v[24:27], v[152:155], v[164:167], v[24:27]
    ds_read_b128 v[196:199], v125 offset:34816
    v_mfma_f32_16x16x32_bf16 v[28:31], v[156:159], v[164:167], v[28:31]
    s_waitcnt lgkmcnt(0)
    buffer_load_dwordx4 v117, s[20:23], s6 offen offset:1024 lds
    v_mfma_f32_16x16x32_bf16 v[32:35], v[144:147], v[168:171], v[32:35]
    ds_read_b64_tr_b16 v[184:185], v122 offset:40960
    v_mfma_f32_16x16x32_bf16 v[36:39], v[148:151], v[168:171], v[36:39]
    ds_read_b64_tr_b16 v[186:187], v122 offset:41984
    v_mfma_f32_16x16x32_bf16 v[40:43], v[152:155], v[168:171], v[40:43]
    ds_read_b64_tr_b16 v[188:189], v123 offset:40960
    v_mfma_f32_16x16x32_bf16 v[44:47], v[156:159], v[168:171], v[44:47]
    buffer_load_dwordx4 v118, s[20:23], s6 offen offset:2048 lds
    v_mfma_f32_16x16x32_bf16 v[48:51], v[144:147], v[172:175], v[48:51]
    ds_read_b64_tr_b16 v[190:191], v123 offset:41984
    v_mfma_f32_16x16x32_bf16 v[52:55], v[148:151], v[172:175], v[52:55]
    ds_read_b128 v[200:203], v125 offset:36864
    v_mfma_f32_16x16x32_bf16 v[56:59], v[152:155], v[172:175], v[56:59]
    ds_read_b128 v[204:207], v125 offset:38912
    v_mfma_f32_16x16x32_bf16 v[60:63], v[156:159], v[172:175], v[60:63]
    s_waitcnt lgkmcnt(0)
    buffer_load_dwordx4 v119, s[20:23], s6 offen offset:3072 lds
    v_mfma_f32_16x16x32_bf16 v[0:3], v[176:179], v[192:195], v[0:3]
    s_waitcnt vmcnt(8)
    s_barrier
    ds_read_b64_tr_b16 v[144:145], v120 offset:49152
    v_mfma_f32_16x16x32_bf16 v[4:7], v[180:183], v[192:195], v[4:7]
    s_add_u32 m0, s7, 49152
    ds_read_b64_tr_b16 v[146:147], v120 offset:50176
    v_mfma_f32_16x16x32_bf16 v[16:19], v[176:179], v[196:199], v[16:19]
    s_or_b32 s6, s4, 4194304
    ds_read_b128 v[160:163], v124 offset:49152
    v_mfma_f32_16x16x32_bf16 v[20:23], v[180:183], v[196:199], v[20:23]
    s_waitcnt lgkmcnt(5)
    buffer_load_dwordx4 v112, s[32:35], s6 offen offset:0 lds
    v_mfma_f32_16x16x32_bf16 v[8:11], v[184:187], v[192:195], v[8:11]
    s_add_u32 s4, s4, 524288
    ds_read_b64_tr_b16 v[148:149], v121 offset:49152
    v_mfma_f32_16x16x32_bf16 v[12:15], v[188:191], v[192:195], v[12:15]
    s_and_b32 s4, s4, 1572864
    ds_read_b64_tr_b16 v[150:151], v121 offset:50176
    v_mfma_f32_16x16x32_bf16 v[24:27], v[184:187], v[196:199], v[24:27]
    ds_read_b128 v[164:167], v124 offset:51200
    v_mfma_f32_16x16x32_bf16 v[28:31], v[188:191], v[196:199], v[28:31]
    s_waitcnt lgkmcnt(0)
    buffer_load_dwordx4 v113, s[32:35], s6 offen offset:1024 lds
    v_mfma_f32_16x16x32_bf16 v[32:35], v[176:179], v[200:203], v[32:35]
    ds_read_b64_tr_b16 v[152:153], v122 offset:49152
    v_mfma_f32_16x16x32_bf16 v[36:39], v[180:183], v[200:203], v[36:39]
    ds_read_b64_tr_b16 v[154:155], v122 offset:50176
    v_mfma_f32_16x16x32_bf16 v[40:43], v[184:187], v[200:203], v[40:43]
    ds_read_b64_tr_b16 v[156:157], v123 offset:49152
    v_mfma_f32_16x16x32_bf16 v[44:47], v[188:191], v[200:203], v[44:47]
    buffer_load_dwordx4 v114, s[32:35], s6 offen offset:2048 lds
    v_mfma_f32_16x16x32_bf16 v[48:51], v[176:179], v[204:207], v[48:51]
    ds_read_b64_tr_b16 v[158:159], v123 offset:50176
    v_mfma_f32_16x16x32_bf16 v[52:55], v[180:183], v[204:207], v[52:55]
    ds_read_b128 v[168:171], v124 offset:53248
    v_mfma_f32_16x16x32_bf16 v[56:59], v[184:187], v[204:207], v[56:59]
    ds_read_b128 v[172:175], v124 offset:55296
    v_mfma_f32_16x16x32_bf16 v[60:63], v[188:191], v[204:207], v[60:63]
    s_waitcnt lgkmcnt(0)
    buffer_load_dwordx4 v115, s[32:35], s6 offen offset:3072 lds
    v_mfma_f32_16x16x32_bf16 v[0:3], v[144:147], v[160:163], v[0:3]
    s_add_u32 m0, s7, 114688
    ds_read_b64_tr_b16 v[176:177], v120 offset:57344
    v_mfma_f32_16x16x32_bf16 v[4:7], v[148:151], v[160:163], v[4:7]
    s_lshr_b32 s6, s6, 12
    ds_read_b64_tr_b16 v[178:179], v120 offset:58368
    v_mfma_f32_16x16x32_bf16 v[16:19], v[144:147], v[164:167], v[16:19]
    ds_read_b128 v[192:195], v125 offset:49152
    v_mfma_f32_16x16x32_bf16 v[20:23], v[148:151], v[164:167], v[20:23]
    s_waitcnt lgkmcnt(5)
    buffer_load_dwordx4 v116, s[20:23], s6 offen offset:0 lds
    v_mfma_f32_16x16x32_bf16 v[8:11], v[152:155], v[160:163], v[8:11]
    ds_read_b64_tr_b16 v[180:181], v121 offset:57344
    v_mfma_f32_16x16x32_bf16 v[12:15], v[156:159], v[160:163], v[12:15]
    ds_read_b64_tr_b16 v[182:183], v121 offset:58368
    v_mfma_f32_16x16x32_bf16 v[24:27], v[152:155], v[164:167], v[24:27]
    ds_read_b128 v[196:199], v125 offset:51200
    v_mfma_f32_16x16x32_bf16 v[28:31], v[156:159], v[164:167], v[28:31]
    s_waitcnt lgkmcnt(0)
    buffer_load_dwordx4 v117, s[20:23], s6 offen offset:1024 lds
    v_mfma_f32_16x16x32_bf16 v[32:35], v[144:147], v[168:171], v[32:35]
    ds_read_b64_tr_b16 v[184:185], v122 offset:57344
    v_mfma_f32_16x16x32_bf16 v[36:39], v[148:151], v[168:171], v[36:39]
    ds_read_b64_tr_b16 v[186:187], v122 offset:58368
    v_mfma_f32_16x16x32_bf16 v[40:43], v[152:155], v[168:171], v[40:43]
    ds_read_b64_tr_b16 v[188:189], v123 offset:57344
    v_mfma_f32_16x16x32_bf16 v[44:47], v[156:159], v[168:171], v[44:47]
    buffer_load_dwordx4 v118, s[20:23], s6 offen offset:2048 lds
    v_mfma_f32_16x16x32_bf16 v[48:51], v[144:147], v[172:175], v[48:51]
    ds_read_b64_tr_b16 v[190:191], v123 offset:58368
    v_mfma_f32_16x16x32_bf16 v[52:55], v[148:151], v[172:175], v[52:55]
    ds_read_b128 v[200:203], v125 offset:53248
    v_mfma_f32_16x16x32_bf16 v[56:59], v[152:155], v[172:175], v[56:59]
    ds_read_b128 v[204:207], v125 offset:55296
    v_mfma_f32_16x16x32_bf16 v[60:63], v[156:159], v[172:175], v[60:63]
    s_waitcnt lgkmcnt(0)
    buffer_load_dwordx4 v119, s[20:23], s6 offen offset:3072 lds
    v_mfma_f32_16x16x32_bf16 v[0:3], v[176:179], v[192:195], v[0:3]
    s_waitcnt vmcnt(8)
    s_barrier
    ds_read_b64_tr_b16 v[144:145], v120 offset:0
    v_mfma_f32_16x16x32_bf16 v[4:7], v[180:183], v[192:195], v[4:7]
    s_add_u32 m0, s7, 65536
    ds_read_b64_tr_b16 v[146:147], v120 offset:1024
    v_mfma_f32_16x16x32_bf16 v[16:19], v[176:179], v[196:199], v[16:19]
    s_or_b32 s6, s4, 4194304
    ds_read_b128 v[160:163], v124 offset:0
    v_mfma_f32_16x16x32_bf16 v[20:23], v[180:183], v[196:199], v[20:23]
    s_waitcnt lgkmcnt(5)
    buffer_load_dwordx4 v112, s[32:35], s6 offen offset:0 lds
    v_mfma_f32_16x16x32_bf16 v[8:11], v[184:187], v[192:195], v[8:11]
    s_add_u32 s4, s4, 524288
    ds_read_b64_tr_b16 v[148:149], v121 offset:0
    v_mfma_f32_16x16x32_bf16 v[12:15], v[188:191], v[192:195], v[12:15]
    s_and_b32 s4, s4, 1572864
    ds_read_b64_tr_b16 v[150:151], v121 offset:1024
    v_mfma_f32_16x16x32_bf16 v[24:27], v[184:187], v[196:199], v[24:27]
    ds_read_b128 v[164:167], v124 offset:2048
    v_mfma_f32_16x16x32_bf16 v[28:31], v[188:191], v[196:199], v[28:31]
    s_waitcnt lgkmcnt(0)
    buffer_load_dwordx4 v113, s[32:35], s6 offen offset:1024 lds
    v_mfma_f32_16x16x32_bf16 v[32:35], v[176:179], v[200:203], v[32:35]
    ds_read_b64_tr_b16 v[152:153], v122 offset:0
    v_mfma_f32_16x16x32_bf16 v[36:39], v[180:183], v[200:203], v[36:39]
    ds_read_b64_tr_b16 v[154:155], v122 offset:1024
    v_mfma_f32_16x16x32_bf16 v[40:43], v[184:187], v[200:203], v[40:43]
    ds_read_b64_tr_b16 v[156:157], v123 offset:0
    v_mfma_f32_16x16x32_bf16 v[44:47], v[188:191], v[200:203], v[44:47]
    buffer_load_dwordx4 v114, s[32:35], s6 offen offset:2048 lds
    v_mfma_f32_16x16x32_bf16 v[48:51], v[176:179], v[204:207], v[48:51]
    ds_read_b64_tr_b16 v[158:159], v123 offset:1024
    v_mfma_f32_16x16x32_bf16 v[52:55], v[180:183], v[204:207], v[52:55]
    ds_read_b128 v[168:171], v124 offset:4096
    v_mfma_f32_16x16x32_bf16 v[56:59], v[184:187], v[204:207], v[56:59]
    ds_read_b128 v[172:175], v124 offset:6144
    v_mfma_f32_16x16x32_bf16 v[60:63], v[188:191], v[204:207], v[60:63]
    s_waitcnt lgkmcnt(0)
    buffer_load_dwordx4 v115, s[32:35], s6 offen offset:3072 lds
    v_mfma_f32_16x16x32_bf16 v[0:3], v[144:147], v[160:163], v[0:3]
    s_add_u32 m0, s7, 131072
    ds_read_b64_tr_b16 v[176:177], v120 offset:8192
    v_mfma_f32_16x16x32_bf16 v[4:7], v[148:151], v[160:163], v[4:7]
    s_lshr_b32 s6, s6, 12
    ds_read_b64_tr_b16 v[178:179], v120 offset:9216
    v_mfma_f32_16x16x32_bf16 v[16:19], v[144:147], v[164:167], v[16:19]
    ds_read_b128 v[192:195], v125 offset:0
    v_mfma_f32_16x16x32_bf16 v[20:23], v[148:151], v[164:167], v[20:23]
    s_waitcnt lgkmcnt(5)
    buffer_load_dwordx4 v116, s[20:23], s6 offen offset:0 lds
    v_mfma_f32_16x16x32_bf16 v[8:11], v[152:155], v[160:163], v[8:11]
    ds_read_b64_tr_b16 v[180:181], v121 offset:8192
    v_mfma_f32_16x16x32_bf16 v[12:15], v[156:159], v[160:163], v[12:15]
    ds_read_b64_tr_b16 v[182:183], v121 offset:9216
    v_mfma_f32_16x16x32_bf16 v[24:27], v[152:155], v[164:167], v[24:27]
    ds_read_b128 v[196:199], v125 offset:2048
    v_mfma_f32_16x16x32_bf16 v[28:31], v[156:159], v[164:167], v[28:31]
    s_waitcnt lgkmcnt(6)
    buffer_load_dwordx4 v117, s[20:23], s6 offen offset:1024 lds
    v_mfma_f32_16x16x32_bf16 v[32:35], v[144:147], v[168:171], v[32:35]
    ds_read_b64_tr_b16 v[184:185], v122 offset:8192
    v_mfma_f32_16x16x32_bf16 v[36:39], v[148:151], v[168:171], v[36:39]
    ds_read_b64_tr_b16 v[186:187], v122 offset:9216
    v_mfma_f32_16x16x32_bf16 v[40:43], v[152:155], v[168:171], v[40:43]
    ds_read_b64_tr_b16 v[188:189], v123 offset:8192
    v_mfma_f32_16x16x32_bf16 v[44:47], v[156:159], v[168:171], v[44:47]
    buffer_load_dwordx4 v118, s[20:23], s6 offen offset:2048 lds
    v_mfma_f32_16x16x32_bf16 v[48:51], v[144:147], v[172:175], v[48:51]
    ds_read_b64_tr_b16 v[190:191], v123 offset:9216
    v_mfma_f32_16x16x32_bf16 v[52:55], v[148:151], v[172:175], v[52:55]
    ds_read_b128 v[200:203], v125 offset:4096
    v_mfma_f32_16x16x32_bf16 v[56:59], v[152:155], v[172:175], v[56:59]
    ds_read_b128 v[204:207], v125 offset:6144
    v_mfma_f32_16x16x32_bf16 v[60:63], v[156:159], v[172:175], v[60:63]
    s_waitcnt lgkmcnt(6)
    buffer_load_dwordx4 v119, s[20:23], s6 offen offset:3072 lds
    v_mfma_f32_16x16x32_bf16 v[0:3], v[176:179], v[192:195], v[0:3]
    s_waitcnt vmcnt(8)
    s_barrier
    ds_read_b64_tr_b16 v[144:145], v120 offset:16384
    v_mfma_f32_16x16x32_bf16 v[4:7], v[180:183], v[192:195], v[4:7]
    s_add_u32 m0, s7, 81920
    ds_read_b64_tr_b16 v[146:147], v120 offset:17408
    v_mfma_f32_16x16x32_bf16 v[16:19], v[176:179], v[196:199], v[16:19]
    s_or_b32 s6, s4, 4194304
    ds_read_b128 v[160:163], v124 offset:16384
    v_mfma_f32_16x16x32_bf16 v[20:23], v[180:183], v[196:199], v[20:23]
    s_waitcnt lgkmcnt(5)
    buffer_load_dwordx4 v112, s[32:35], s6 offen offset:0 lds
    v_mfma_f32_16x16x32_bf16 v[8:11], v[184:187], v[192:195], v[8:11]
    s_add_u32 s4, s4, 524288
    ds_read_b64_tr_b16 v[148:149], v121 offset:16384
    v_mfma_f32_16x16x32_bf16 v[12:15], v[188:191], v[192:195], v[12:15]
    s_and_b32 s4, s4, 1572864
    ds_read_b64_tr_b16 v[150:151], v121 offset:17408
    v_mfma_f32_16x16x32_bf16 v[24:27], v[184:187], v[196:199], v[24:27]
    ds_read_b128 v[164:167], v124 offset:18432
    v_mfma_f32_16x16x32_bf16 v[28:31], v[188:191], v[196:199], v[28:31]
    s_waitcnt lgkmcnt(6)
    buffer_load_dwordx4 v113, s[32:35], s6 offen offset:1024 lds
    v_mfma_f32_16x16x32_bf16 v[32:35], v[176:179], v[200:203], v[32:35]
    ds_read_b64_tr_b16 v[152:153], v122 offset:16384
    v_mfma_f32_16x16x32_bf16 v[36:39], v[180:183], v[200:203], v[36:39]
    ds_read_b64_tr_b16 v[154:155], v122 offset:17408
    v_mfma_f32_16x16x32_bf16 v[40:43], v[184:187], v[200:203], v[40:43]
    ds_read_b64_tr_b16 v[156:157], v123 offset:16384
    v_mfma_f32_16x16x32_bf16 v[44:47], v[188:191], v[200:203], v[44:47]
    buffer_load_dwordx4 v114, s[32:35], s6 offen offset:2048 lds
    v_mfma_f32_16x16x32_bf16 v[48:51], v[176:179], v[204:207], v[48:51]
    ds_read_b64_tr_b16 v[158:159], v123 offset:17408
    v_mfma_f32_16x16x32_bf16 v[52:55], v[180:183], v[204:207], v[52:55]
    ds_read_b128 v[168:171], v124 offset:20480
    v_mfma_f32_16x16x32_bf16 v[56:59], v[184:187], v[204:207], v[56:59]
    ds_read_b128 v[172:175], v124 offset:22528
    v_mfma_f32_16x16x32_bf16 v[60:63], v[188:191], v[204:207], v[60:63]
    s_waitcnt lgkmcnt(6)
    buffer_load_dwordx4 v115, s[32:35], s6 offen offset:3072 lds
    v_mfma_f32_16x16x32_bf16 v[0:3], v[144:147], v[160:163], v[0:3]
    s_add_u32 m0, s7, 147456
    ds_read_b64_tr_b16 v[176:177], v120 offset:24576
    v_mfma_f32_16x16x32_bf16 v[4:7], v[148:151], v[160:163], v[4:7]
    s_lshr_b32 s6, s6, 12
    ds_read_b64_tr_b16 v[178:179], v120 offset:25600
    v_mfma_f32_16x16x32_bf16 v[16:19], v[144:147], v[164:167], v[16:19]
    ds_read_b128 v[192:195], v125 offset:16384
    v_mfma_f32_16x16x32_bf16 v[20:23], v[148:151], v[164:167], v[20:23]
    s_waitcnt lgkmcnt(5)
    buffer_load_dwordx4 v116, s[20:23], s6 offen offset:0 lds
    v_mfma_f32_16x16x32_bf16 v[8:11], v[152:155], v[160:163], v[8:11]
    ds_read_b64_tr_b16 v[180:181], v121 offset:24576
    v_mfma_f32_16x16x32_bf16 v[12:15], v[156:159], v[160:163], v[12:15]
    ds_read_b64_tr_b16 v[182:183], v121 offset:25600
    v_mfma_f32_16x16x32_bf16 v[24:27], v[152:155], v[164:167], v[24:27]
    ds_read_b128 v[196:199], v125 offset:18432
    v_mfma_f32_16x16x32_bf16 v[28:31], v[156:159], v[164:167], v[28:31]
    s_waitcnt lgkmcnt(6)
    buffer_load_dwordx4 v117, s[20:23], s6 offen offset:1024 lds
    v_mfma_f32_16x16x32_bf16 v[32:35], v[144:147], v[168:171], v[32:35]
    ds_read_b64_tr_b16 v[184:185], v122 offset:24576
    v_mfma_f32_16x16x32_bf16 v[36:39], v[148:151], v[168:171], v[36:39]
    ds_read_b64_tr_b16 v[186:187], v122 offset:25600
    v_mfma_f32_16x16x32_bf16 v[40:43], v[152:155], v[168:171], v[40:43]
    ds_read_b64_tr_b16 v[188:189], v123 offset:24576
    v_mfma_f32_16x16x32_bf16 v[44:47], v[156:159], v[168:171], v[44:47]
    buffer_load_dwordx4 v118, s[20:23], s6 offen offset:2048 lds
    v_mfma_f32_16x16x32_bf16 v[48:51], v[144:147], v[172:175], v[48:51]
    ds_read_b64_tr_b16 v[190:191], v123 offset:25600
    v_mfma_f32_16x16x32_bf16 v[52:55], v[148:151], v[172:175], v[52:55]
    ds_read_b128 v[200:203], v125 offset:20480
    v_mfma_f32_16x16x32_bf16 v[56:59], v[152:155], v[172:175], v[56:59]
    ds_read_b128 v[204:207], v125 offset:22528
    v_mfma_f32_16x16x32_bf16 v[60:63], v[156:159], v[172:175], v[60:63]
    s_waitcnt lgkmcnt(6)
    buffer_load_dwordx4 v119, s[20:23], s6 offen offset:3072 lds
    v_mfma_f32_16x16x32_bf16 v[0:3], v[176:179], v[192:195], v[0:3]
    s_waitcnt vmcnt(8)
    s_barrier
    ds_read_b64_tr_b16 v[144:145], v120 offset:32768
    v_mfma_f32_16x16x32_bf16 v[4:7], v[180:183], v[192:195], v[4:7]
    s_add_u32 m0, s7, 32768
    ds_read_b64_tr_b16 v[146:147], v120 offset:33792
    v_mfma_f32_16x16x32_bf16 v[16:19], v[176:179], v[196:199], v[16:19]
    s_or_b32 s6, s4, 6291456
    ds_read_b128 v[160:163], v124 offset:32768
    v_mfma_f32_16x16x32_bf16 v[20:23], v[180:183], v[196:199], v[20:23]
    s_waitcnt lgkmcnt(5)
    buffer_load_dwordx4 v112, s[32:35], s6 offen offset:0 lds
    v_mfma_f32_16x16x32_bf16 v[8:11], v[184:187], v[192:195], v[8:11]
    s_add_u32 s4, s4, 524288
    ds_read_b64_tr_b16 v[148:149], v121 offset:32768
    v_mfma_f32_16x16x32_bf16 v[12:15], v[188:191], v[192:195], v[12:15]
    s_and_b32 s4, s4, 1572864
    ds_read_b64_tr_b16 v[150:151], v121 offset:33792
    v_mfma_f32_16x16x32_bf16 v[24:27], v[184:187], v[196:199], v[24:27]
    ds_read_b128 v[164:167], v124 offset:34816
    v_mfma_f32_16x16x32_bf16 v[28:31], v[188:191], v[196:199], v[28:31]
    s_waitcnt lgkmcnt(6)
    buffer_load_dwordx4 v113, s[32:35], s6 offen offset:1024 lds
    v_mfma_f32_16x16x32_bf16 v[32:35], v[176:179], v[200:203], v[32:35]
    ds_read_b64_tr_b16 v[152:153], v122 offset:32768
    v_mfma_f32_16x16x32_bf16 v[36:39], v[180:183], v[200:203], v[36:39]
    ds_read_b64_tr_b16 v[154:155], v122 offset:33792
    v_mfma_f32_16x16x32_bf16 v[40:43], v[184:187], v[200:203], v[40:43]
    ds_read_b64_tr_b16 v[156:157], v123 offset:32768
    v_mfma_f32_16x16x32_bf16 v[44:47], v[188:191], v[200:203], v[44:47]
    buffer_load_dwordx4 v114, s[32:35], s6 offen offset:2048 lds
    v_mfma_f32_16x16x32_bf16 v[48:51], v[176:179], v[204:207], v[48:51]
    ds_read_b64_tr_b16 v[158:159], v123 offset:33792
    v_mfma_f32_16x16x32_bf16 v[52:55], v[180:183], v[204:207], v[52:55]
    ds_read_b128 v[168:171], v124 offset:36864
    v_mfma_f32_16x16x32_bf16 v[56:59], v[184:187], v[204:207], v[56:59]
    ds_read_b128 v[172:175], v124 offset:38912
    v_mfma_f32_16x16x32_bf16 v[60:63], v[188:191], v[204:207], v[60:63]
    s_waitcnt lgkmcnt(6)
    buffer_load_dwordx4 v115, s[32:35], s6 offen offset:3072 lds
    v_mfma_f32_16x16x32_bf16 v[0:3], v[144:147], v[160:163], v[0:3]
    s_add_u32 m0, s7, 98304
    ds_read_b64_tr_b16 v[176:177], v120 offset:40960
    v_mfma_f32_16x16x32_bf16 v[4:7], v[148:151], v[160:163], v[4:7]
    s_lshr_b32 s6, s6, 12
    ds_read_b64_tr_b16 v[178:179], v120 offset:41984
    v_mfma_f32_16x16x32_bf16 v[16:19], v[144:147], v[164:167], v[16:19]
    ds_read_b128 v[192:195], v125 offset:32768
    v_mfma_f32_16x16x32_bf16 v[20:23], v[148:151], v[164:167], v[20:23]
    s_waitcnt lgkmcnt(5)
    buffer_load_dwordx4 v116, s[20:23], s6 offen offset:0 lds
    v_mfma_f32_16x16x32_bf16 v[8:11], v[152:155], v[160:163], v[8:11]
    ds_read_b64_tr_b16 v[180:181], v121 offset:40960
    v_mfma_f32_16x16x32_bf16 v[12:15], v[156:159], v[160:163], v[12:15]
    ds_read_b64_tr_b16 v[182:183], v121 offset:41984
    v_mfma_f32_16x16x32_bf16 v[24:27], v[152:155], v[164:167], v[24:27]
    ds_read_b128 v[196:199], v125 offset:34816
    v_mfma_f32_16x16x32_bf16 v[28:31], v[156:159], v[164:167], v[28:31]
    s_waitcnt lgkmcnt(6)
    buffer_load_dwordx4 v117, s[20:23], s6 offen offset:1024 lds
    v_mfma_f32_16x16x32_bf16 v[32:35], v[144:147], v[168:171], v[32:35]
    ds_read_b64_tr_b16 v[184:185], v122 offset:40960
    v_mfma_f32_16x16x32_bf16 v[36:39], v[148:151], v[168:171], v[36:39]
    ds_read_b64_tr_b16 v[186:187], v122 offset:41984
    v_mfma_f32_16x16x32_bf16 v[40:43], v[152:155], v[168:171], v[40:43]
    ds_read_b64_tr_b16 v[188:189], v123 offset:40960
    v_mfma_f32_16x16x32_bf16 v[44:47], v[156:159], v[168:171], v[44:47]
    buffer_load_dwordx4 v118, s[20:23], s6 offen offset:2048 lds
    v_mfma_f32_16x16x32_bf16 v[48:51], v[144:147], v[172:175], v[48:51]
    ds_read_b64_tr_b16 v[190:191], v123 offset:41984
    v_mfma_f32_16x16x32_bf16 v[52:55], v[148:151], v[172:175], v[52:55]
    ds_read_b128 v[200:203], v125 offset:36864
    v_mfma_f32_16x16x32_bf16 v[56:59], v[152:155], v[172:175], v[56:59]
    ds_read_b128 v[204:207], v125 offset:38912
    v_mfma_f32_16x16x32_bf16 v[60:63], v[156:159], v[172:175], v[60:63]
    s_waitcnt lgkmcnt(6)
    buffer_load_dwordx4 v119, s[20:23], s6 offen offset:3072 lds
    v_mfma_f32_16x16x32_bf16 v[0:3], v[176:179], v[192:195], v[0:3]
    s_waitcnt vmcnt(8)
    s_barrier
    ds_read_b64_tr_b16 v[144:145], v120 offset:49152
    v_mfma_f32_16x16x32_bf16 v[4:7], v[180:183], v[192:195], v[4:7]
    s_add_u32 m0, s7, 49152
    ds_read_b64_tr_b16 v[146:147], v120 offset:50176
    v_mfma_f32_16x16x32_bf16 v[16:19], v[176:179], v[196:199], v[16:19]
    s_or_b32 s6, s4, 6291456
    ds_read_b128 v[160:163], v124 offset:49152
    v_mfma_f32_16x16x32_bf16 v[20:23], v[180:183], v[196:199], v[20:23]
    s_waitcnt lgkmcnt(5)
    buffer_load_dwordx4 v112, s[32:35], s6 offen offset:0 lds
    v_mfma_f32_16x16x32_bf16 v[8:11], v[184:187], v[192:195], v[8:11]
    s_add_u32 s4, s4, 524288
    ds_read_b64_tr_b16 v[148:149], v121 offset:49152
    v_mfma_f32_16x16x32_bf16 v[12:15], v[188:191], v[192:195], v[12:15]
    s_and_b32 s4, s4, 1572864
    ds_read_b64_tr_b16 v[150:151], v121 offset:50176
    v_mfma_f32_16x16x32_bf16 v[24:27], v[184:187], v[196:199], v[24:27]
    ds_read_b128 v[164:167], v124 offset:51200
    v_mfma_f32_16x16x32_bf16 v[28:31], v[188:191], v[196:199], v[28:31]
    s_waitcnt lgkmcnt(6)
    buffer_load_dwordx4 v113, s[32:35], s6 offen offset:1024 lds
    v_mfma_f32_16x16x32_bf16 v[32:35], v[176:179], v[200:203], v[32:35]
    ds_read_b64_tr_b16 v[152:153], v122 offset:49152
    v_mfma_f32_16x16x32_bf16 v[36:39], v[180:183], v[200:203], v[36:39]
    ds_read_b64_tr_b16 v[154:155], v122 offset:50176
    v_mfma_f32_16x16x32_bf16 v[40:43], v[184:187], v[200:203], v[40:43]
    ds_read_b64_tr_b16 v[156:157], v123 offset:49152
    v_mfma_f32_16x16x32_bf16 v[44:47], v[188:191], v[200:203], v[44:47]
    buffer_load_dwordx4 v114, s[32:35], s6 offen offset:2048 lds
    v_mfma_f32_16x16x32_bf16 v[48:51], v[176:179], v[204:207], v[48:51]
    ds_read_b64_tr_b16 v[158:159], v123 offset:50176
    v_mfma_f32_16x16x32_bf16 v[52:55], v[180:183], v[204:207], v[52:55]
    ds_read_b128 v[168:171], v124 offset:53248
    v_mfma_f32_16x16x32_bf16 v[56:59], v[184:187], v[204:207], v[56:59]
    ds_read_b128 v[172:175], v124 offset:55296
    v_mfma_f32_16x16x32_bf16 v[60:63], v[188:191], v[204:207], v[60:63]
    s_waitcnt lgkmcnt(6)
    buffer_load_dwordx4 v115, s[32:35], s6 offen offset:3072 lds
    v_mfma_f32_16x16x32_bf16 v[0:3], v[144:147], v[160:163], v[0:3]
    s_add_u32 m0, s7, 114688
    ds_read_b64_tr_b16 v[176:177], v120 offset:57344
    v_mfma_f32_16x16x32_bf16 v[4:7], v[148:151], v[160:163], v[4:7]
    s_lshr_b32 s6, s6, 12
    ds_read_b64_tr_b16 v[178:179], v120 offset:58368
    v_mfma_f32_16x16x32_bf16 v[16:19], v[144:147], v[164:167], v[16:19]
    ds_read_b128 v[192:195], v125 offset:49152
    v_mfma_f32_16x16x32_bf16 v[20:23], v[148:151], v[164:167], v[20:23]
    s_waitcnt lgkmcnt(5)
    buffer_load_dwordx4 v116, s[20:23], s6 offen offset:0 lds
    v_mfma_f32_16x16x32_bf16 v[8:11], v[152:155], v[160:163], v[8:11]
    ds_read_b64_tr_b16 v[180:181], v121 offset:57344
    v_mfma_f32_16x16x32_bf16 v[12:15], v[156:159], v[160:163], v[12:15]
    ds_read_b64_tr_b16 v[182:183], v121 offset:58368
    v_mfma_f32_16x16x32_bf16 v[24:27], v[152:155], v[164:167], v[24:27]
    ds_read_b128 v[196:199], v125 offset:51200
    v_mfma_f32_16x16x32_bf16 v[28:31], v[156:159], v[164:167], v[28:31]
    s_waitcnt lgkmcnt(6)
    buffer_load_dwordx4 v117, s[20:23], s6 offen offset:1024 lds
    v_mfma_f32_16x16x32_bf16 v[32:35], v[144:147], v[168:171], v[32:35]
    ds_read_b64_tr_b16 v[184:185], v122 offset:57344
    v_mfma_f32_16x16x32_bf16 v[36:39], v[148:151], v[168:171], v[36:39]
    ds_read_b64_tr_b16 v[186:187], v122 offset:58368
    v_mfma_f32_16x16x32_bf16 v[40:43], v[152:155], v[168:171], v[40:43]
    ds_read_b64_tr_b16 v[188:189], v123 offset:57344
    v_mfma_f32_16x16x32_bf16 v[44:47], v[156:159], v[168:171], v[44:47]
    buffer_load_dwordx4 v118, s[20:23], s6 offen offset:2048 lds
    v_mfma_f32_16x16x32_bf16 v[48:51], v[144:147], v[172:175], v[48:51]
    ds_read_b64_tr_b16 v[190:191], v123 offset:58368
    v_mfma_f32_16x16x32_bf16 v[52:55], v[148:151], v[172:175], v[52:55]
    ds_read_b128 v[200:203], v125 offset:53248
    v_mfma_f32_16x16x32_bf16 v[56:59], v[152:155], v[172:175], v[56:59]
    ds_read_b128 v[204:207], v125 offset:55296
    v_mfma_f32_16x16x32_bf16 v[60:63], v[156:159], v[172:175], v[60:63]
    s_waitcnt lgkmcnt(6)
    buffer_load_dwordx4 v119, s[20:23], s6 offen offset:3072 lds
    v_mfma_f32_16x16x32_bf16 v[0:3], v[176:179], v[192:195], v[0:3]
    s_waitcnt vmcnt(8)
    s_barrier
    ds_read_b64_tr_b16 v[144:145], v120 offset:0
    v_mfma_f32_16x16x32_bf16 v[4:7], v[180:183], v[192:195], v[4:7]
    s_add_u32 m0, s7, 65536
    ds_read_b64_tr_b16 v[146:147], v120 offset:1024
    v_mfma_f32_16x16x32_bf16 v[16:19], v[176:179], v[196:199], v[16:19]
    s_or_b32 s6, s4, 6291456
    ds_read_b128 v[160:163], v124 offset:0
    v_mfma_f32_16x16x32_bf16 v[20:23], v[180:183], v[196:199], v[20:23]
    s_waitcnt lgkmcnt(5)
    buffer_load_dwordx4 v112, s[32:35], s6 offen offset:0 lds
    v_mfma_f32_16x16x32_bf16 v[8:11], v[184:187], v[192:195], v[8:11]
    s_add_u32 s4, s4, 524288
    ds_read_b64_tr_b16 v[148:149], v121 offset:0
    v_mfma_f32_16x16x32_bf16 v[12:15], v[188:191], v[192:195], v[12:15]
    s_and_b32 s4, s4, 1572864
    ds_read_b64_tr_b16 v[150:151], v121 offset:1024
    v_mfma_f32_16x16x32_bf16 v[24:27], v[184:187], v[196:199], v[24:27]
    ds_read_b128 v[164:167], v124 offset:2048
    v_mfma_f32_16x16x32_bf16 v[28:31], v[188:191], v[196:199], v[28:31]
    s_waitcnt lgkmcnt(6)
    buffer_load_dwordx4 v113, s[32:35], s6 offen offset:1024 lds
    v_mfma_f32_16x16x32_bf16 v[32:35], v[176:179], v[200:203], v[32:35]
    ds_read_b64_tr_b16 v[152:153], v122 offset:0
    v_mfma_f32_16x16x32_bf16 v[36:39], v[180:183], v[200:203], v[36:39]
    ds_read_b64_tr_b16 v[154:155], v122 offset:1024
    v_mfma_f32_16x16x32_bf16 v[40:43], v[184:187], v[200:203], v[40:43]
    ds_read_b64_tr_b16 v[156:157], v123 offset:0
    v_mfma_f32_16x16x32_bf16 v[44:47], v[188:191], v[200:203], v[44:47]
    buffer_load_dwordx4 v114, s[32:35], s6 offen offset:2048 lds
    v_mfma_f32_16x16x32_bf16 v[48:51], v[176:179], v[204:207], v[48:51]
    ds_read_b64_tr_b16 v[158:159], v123 offset:1024
    v_mfma_f32_16x16x32_bf16 v[52:55], v[180:183], v[204:207], v[52:55]
    ds_read_b128 v[168:171], v124 offset:4096
    v_mfma_f32_16x16x32_bf16 v[56:59], v[184:187], v[204:207], v[56:59]
    ds_read_b128 v[172:175], v124 offset:6144
    v_mfma_f32_16x16x32_bf16 v[60:63], v[188:191], v[204:207], v[60:63]
    s_waitcnt lgkmcnt(6)
    buffer_load_dwordx4 v115, s[32:35], s6 offen offset:3072 lds
    v_mfma_f32_16x16x32_bf16 v[0:3], v[144:147], v[160:163], v[0:3]
    s_add_u32 m0, s7, 131072
    ds_read_b64_tr_b16 v[176:177], v120 offset:8192
    v_mfma_f32_16x16x32_bf16 v[4:7], v[148:151], v[160:163], v[4:7]
    s_lshr_b32 s6, s6, 12
    ds_read_b64_tr_b16 v[178:179], v120 offset:9216
    v_mfma_f32_16x16x32_bf16 v[16:19], v[144:147], v[164:167], v[16:19]
    ds_read_b128 v[192:195], v125 offset:0
    v_mfma_f32_16x16x32_bf16 v[20:23], v[148:151], v[164:167], v[20:23]
    s_waitcnt lgkmcnt(5)
    buffer_load_dwordx4 v116, s[20:23], s6 offen offset:0 lds
    v_mfma_f32_16x16x32_bf16 v[8:11], v[152:155], v[160:163], v[8:11]
    ds_read_b64_tr_b16 v[180:181], v121 offset:8192
    v_mfma_f32_16x16x32_bf16 v[12:15], v[156:159], v[160:163], v[12:15]
    ds_read_b64_tr_b16 v[182:183], v121 offset:9216
    v_mfma_f32_16x16x32_bf16 v[24:27], v[152:155], v[164:167], v[24:27]
    ds_read_b128 v[196:199], v125 offset:2048
    v_mfma_f32_16x16x32_bf16 v[28:31], v[156:159], v[164:167], v[28:31]
    s_waitcnt lgkmcnt(6)
    buffer_load_dwordx4 v117, s[20:23], s6 offen offset:1024 lds
    v_mfma_f32_16x16x32_bf16 v[32:35], v[144:147], v[168:171], v[32:35]
    ds_read_b64_tr_b16 v[184:185], v122 offset:8192
    v_mfma_f32_16x16x32_bf16 v[36:39], v[148:151], v[168:171], v[36:39]
    ds_read_b64_tr_b16 v[186:187], v122 offset:9216
    v_mfma_f32_16x16x32_bf16 v[40:43], v[152:155], v[168:171], v[40:43]
    ds_read_b64_tr_b16 v[188:189], v123 offset:8192
    v_mfma_f32_16x16x32_bf16 v[44:47], v[156:159], v[168:171], v[44:47]
    buffer_load_dwordx4 v118, s[20:23], s6 offen offset:2048 lds
    v_mfma_f32_16x16x32_bf16 v[48:51], v[144:147], v[172:175], v[48:51]
    ds_read_b64_tr_b16 v[190:191], v123 offset:9216
    v_mfma_f32_16x16x32_bf16 v[52:55], v[148:151], v[172:175], v[52:55]
    ds_read_b128 v[200:203], v125 offset:4096
    v_mfma_f32_16x16x32_bf16 v[56:59], v[152:155], v[172:175], v[56:59]
    ds_read_b128 v[204:207], v125 offset:6144
    v_mfma_f32_16x16x32_bf16 v[60:63], v[156:159], v[172:175], v[60:63]
    s_waitcnt lgkmcnt(6)
    buffer_load_dwordx4 v119, s[20:23], s6 offen offset:3072 lds
    v_mfma_f32_16x16x32_bf16 v[0:3], v[176:179], v[192:195], v[0:3]
    s_waitcnt vmcnt(8)
    s_barrier
    ds_read_b64_tr_b16 v[144:145], v120 offset:16384
    v_mfma_f32_16x16x32_bf16 v[4:7], v[180:183], v[192:195], v[4:7]
    s_add_u32 m0, s7, 81920
    ds_read_b64_tr_b16 v[146:147], v120 offset:17408
    v_mfma_f32_16x16x32_bf16 v[16:19], v[176:179], v[196:199], v[16:19]
    s_or_b32 s6, s4, 6291456
    ds_read_b128 v[160:163], v124 offset:16384
    v_mfma_f32_16x16x32_bf16 v[20:23], v[180:183], v[196:199], v[20:23]
    s_waitcnt lgkmcnt(5)
    buffer_load_dwordx4 v112, s[32:35], s6 offen offset:0 lds
    v_mfma_f32_16x16x32_bf16 v[8:11], v[184:187], v[192:195], v[8:11]
    s_add_u32 s4, s4, 524288
    ds_read_b64_tr_b16 v[148:149], v121 offset:16384
    v_mfma_f32_16x16x32_bf16 v[12:15], v[188:191], v[192:195], v[12:15]
    s_and_b32 s4, s4, 1572864
    ds_read_b64_tr_b16 v[150:151], v121 offset:17408
    v_mfma_f32_16x16x32_bf16 v[24:27], v[184:187], v[196:199], v[24:27]
    ds_read_b128 v[164:167], v124 offset:18432
    v_mfma_f32_16x16x32_bf16 v[28:31], v[188:191], v[196:199], v[28:31]
    s_waitcnt lgkmcnt(6)
    buffer_load_dwordx4 v113, s[32:35], s6 offen offset:1024 lds
    v_mfma_f32_16x16x32_bf16 v[32:35], v[176:179], v[200:203], v[32:35]
    ds_read_b64_tr_b16 v[152:153], v122 offset:16384
    v_mfma_f32_16x16x32_bf16 v[36:39], v[180:183], v[200:203], v[36:39]
    ds_read_b64_tr_b16 v[154:155], v122 offset:17408
    v_mfma_f32_16x16x32_bf16 v[40:43], v[184:187], v[200:203], v[40:43]
    ds_read_b64_tr_b16 v[156:157], v123 offset:16384
    v_mfma_f32_16x16x32_bf16 v[44:47], v[188:191], v[200:203], v[44:47]
    buffer_load_dwordx4 v114, s[32:35], s6 offen offset:2048 lds
    v_mfma_f32_16x16x32_bf16 v[48:51], v[176:179], v[204:207], v[48:51]
    ds_read_b64_tr_b16 v[158:159], v123 offset:17408
    v_mfma_f32_16x16x32_bf16 v[52:55], v[180:183], v[204:207], v[52:55]
    ds_read_b128 v[168:171], v124 offset:20480
    v_mfma_f32_16x16x32_bf16 v[56:59], v[184:187], v[204:207], v[56:59]
    ds_read_b128 v[172:175], v124 offset:22528
    v_mfma_f32_16x16x32_bf16 v[60:63], v[188:191], v[204:207], v[60:63]
    s_waitcnt lgkmcnt(6)
    buffer_load_dwordx4 v115, s[32:35], s6 offen offset:3072 lds
    v_mfma_f32_16x16x32_bf16 v[0:3], v[144:147], v[160:163], v[0:3]
    s_add_u32 m0, s7, 147456
    ds_read_b64_tr_b16 v[176:177], v120 offset:24576
    v_mfma_f32_16x16x32_bf16 v[4:7], v[148:151], v[160:163], v[4:7]
    s_lshr_b32 s6, s6, 12
    ds_read_b64_tr_b16 v[178:179], v120 offset:25600
    v_mfma_f32_16x16x32_bf16 v[16:19], v[144:147], v[164:167], v[16:19]
    ds_read_b128 v[192:195], v125 offset:16384
    v_mfma_f32_16x16x32_bf16 v[20:23], v[148:151], v[164:167], v[20:23]
    s_waitcnt lgkmcnt(5)
    buffer_load_dwordx4 v116, s[20:23], s6 offen offset:0 lds
    v_mfma_f32_16x16x32_bf16 v[8:11], v[152:155], v[160:163], v[8:11]
    ds_read_b64_tr_b16 v[180:181], v121 offset:24576
    v_mfma_f32_16x16x32_bf16 v[12:15], v[156:159], v[160:163], v[12:15]
    ds_read_b64_tr_b16 v[182:183], v121 offset:25600
    v_mfma_f32_16x16x32_bf16 v[24:27], v[152:155], v[164:167], v[24:27]
    ds_read_b128 v[196:199], v125 offset:18432
    v_mfma_f32_16x16x32_bf16 v[28:31], v[156:159], v[164:167], v[28:31]
    s_waitcnt lgkmcnt(6)
    buffer_load_dwordx4 v117, s[20:23], s6 offen offset:1024 lds
    v_mfma_f32_16x16x32_bf16 v[32:35], v[144:147], v[168:171], v[32:35]
    ds_read_b64_tr_b16 v[184:185], v122 offset:24576
    v_mfma_f32_16x16x32_bf16 v[36:39], v[148:151], v[168:171], v[36:39]
    ds_read_b64_tr_b16 v[186:187], v122 offset:25600
    v_mfma_f32_16x16x32_bf16 v[40:43], v[152:155], v[168:171], v[40:43]
    ds_read_b64_tr_b16 v[188:189], v123 offset:24576
    v_mfma_f32_16x16x32_bf16 v[44:47], v[156:159], v[168:171], v[44:47]
    buffer_load_dwordx4 v118, s[20:23], s6 offen offset:2048 lds
    v_mfma_f32_16x16x32_bf16 v[48:51], v[144:147], v[172:175], v[48:51]
    ds_read_b64_tr_b16 v[190:191], v123 offset:25600
    v_mfma_f32_16x16x32_bf16 v[52:55], v[148:151], v[172:175], v[52:55]
    ds_read_b128 v[200:203], v125 offset:20480
    v_mfma_f32_16x16x32_bf16 v[56:59], v[152:155], v[172:175], v[56:59]
    ds_read_b128 v[204:207], v125 offset:22528
    v_mfma_f32_16x16x32_bf16 v[60:63], v[156:159], v[172:175], v[60:63]
    s_waitcnt lgkmcnt(6)
    buffer_load_dwordx4 v119, s[20:23], s6 offen offset:3072 lds
    v_mfma_f32_16x16x32_bf16 v[0:3], v[176:179], v[192:195], v[0:3]
    s_waitcnt vmcnt(8)
    s_barrier
    ds_read_b64_tr_b16 v[144:145], v120 offset:32768
    v_mfma_f32_16x16x32_bf16 v[4:7], v[180:183], v[192:195], v[4:7]
    v_mov_b32 v108, 0
    ds_read_b64_tr_b16 v[146:147], v120 offset:33792
    v_mfma_f32_16x16x32_bf16 v[16:19], v[176:179], v[196:199], v[16:19]
    ds_read_b128 v[160:163], v124 offset:32768
    v_mfma_f32_16x16x32_bf16 v[20:23], v[180:183], v[196:199], v[20:23]
    s_waitcnt lgkmcnt(5)
    buffer_load_dword v108, v108, s[48:51], 0 offen sc1
    v_mfma_f32_16x16x32_bf16 v[8:11], v[184:187], v[192:195], v[8:11]
    s_add_u32 m0, s70, 2080
    ds_read_b64_tr_b16 v[148:149], v121 offset:32768
    v_mfma_f32_16x16x32_bf16 v[12:15], v[188:191], v[192:195], v[12:15]
    s_nop 0
    ds_read_b64_tr_b16 v[150:151], v121 offset:33792
    v_mfma_f32_16x16x32_bf16 v[24:27], v[184:187], v[196:199], v[24:27]
    ds_read_b128 v[164:167], v124 offset:34816
    v_mfma_f32_16x16x32_bf16 v[28:31], v[188:191], v[196:199], v[28:31]
    s_waitcnt lgkmcnt(6)
    buffer_load_dwordx4 v238, s[24:27], s66 offen nt lds
    v_mfma_f32_16x16x32_bf16 v[32:35], v[176:179], v[200:203], v[32:35]
    ds_read_b64_tr_b16 v[152:153], v122 offset:32768
    v_mfma_f32_16x16x32_bf16 v[36:39], v[180:183], v[200:203], v[36:39]
    ds_read_b64_tr_b16 v[154:155], v122 offset:33792
    v_mfma_f32_16x16x32_bf16 v[40:43], v[184:187], v[200:203], v[40:43]
    ds_read_b64_tr_b16 v[156:157], v123 offset:32768
    v_mfma_f32_16x16x32_bf16 v[44:47], v[188:191], v[200:203], v[44:47]
    buffer_load_dwordx4 v239, s[24:27], s66 offen offset:1056 nt lds
    v_mfma_f32_16x16x32_bf16 v[48:51], v[176:179], v[204:207], v[48:51]
    s_mov_b32 m0, s71
    ds_read_b64_tr_b16 v[158:159], v123 offset:33792
    v_mfma_f32_16x16x32_bf16 v[52:55], v[180:183], v[204:207], v[52:55]
    s_add_u32 s71, s71, 16640
    ds_read_b128 v[168:171], v124 offset:36864
    v_mfma_f32_16x16x32_bf16 v[56:59], v[184:187], v[204:207], v[56:59]
    ds_read_b128 v[172:175], v124 offset:38912
    v_mfma_f32_16x16x32_bf16 v[60:63], v[188:191], v[204:207], v[60:63]
    s_waitcnt lgkmcnt(6)
    buffer_load_dwordx4 v236, s[24:27], s66 offen offset:2080 nt lds
    v_mfma_f32_16x16x32_bf16 v[0:3], v[144:147], v[160:163], v[0:3]
    ds_read_b64_tr_b16 v[176:177], v120 offset:40960
    v_mfma_f32_16x16x32_bf16 v[4:7], v[148:151], v[160:163], v[4:7]
    ds_read_b64_tr_b16 v[178:179], v120 offset:41984
    v_mfma_f32_16x16x32_bf16 v[16:19], v[144:147], v[164:167], v[16:19]
    ds_read_b128 v[192:195], v125 offset:32768
    v_mfma_f32_16x16x32_bf16 v[20:23], v[148:151], v[164:167], v[20:23]
    s_waitcnt lgkmcnt(5)
    buffer_load_dwordx4 v237, s[24:27], s66 offen offset:3136 nt lds
    v_mfma_f32_16x16x32_bf16 v[8:11], v[152:155], v[160:163], v[8:11]
    ds_read_b64_tr_b16 v[180:181], v121 offset:40960
    v_mfma_f32_16x16x32_bf16 v[12:15], v[156:159], v[160:163], v[12:15]
    ds_read_b64_tr_b16 v[182:183], v121 offset:41984
    v_mfma_f32_16x16x32_bf16 v[24:27], v[152:155], v[164:167], v[24:27]
    ds_read_b128 v[196:199], v125 offset:34816
    v_mfma_f32_16x16x32_bf16 v[28:31], v[156:159], v[164:167], v[28:31]
    s_waitcnt lgkmcnt(6)
    buffer_load_dwordx4 v238, s[28:31], s66 offen nt lds
    v_mfma_f32_16x16x32_bf16 v[32:35], v[144:147], v[168:171], v[32:35]
    ds_read_b64_tr_b16 v[184:185], v122 offset:40960
    v_mfma_f32_16x16x32_bf16 v[36:39], v[148:151], v[168:171], v[36:39]
    ds_read_b64_tr_b16 v[186:187], v122 offset:41984
    v_mfma_f32_16x16x32_bf16 v[40:43], v[152:155], v[168:171], v[40:43]
    ds_read_b64_tr_b16 v[188:189], v123 offset:40960
    v_mfma_f32_16x16x32_bf16 v[44:47], v[156:159], v[168:171], v[44:47]
    buffer_load_dwordx4 v239, s[28:31], s66 offen offset:1056 nt lds
    v_mfma_f32_16x16x32_bf16 v[48:51], v[144:147], v[172:175], v[48:51]
    s_add_u32 s66, s66, 8192
    ds_read_b64_tr_b16 v[190:191], v123 offset:41984
    v_mfma_f32_16x16x32_bf16 v[52:55], v[148:151], v[172:175], v[52:55]
    s_cmp_eq_u32 s71, s76
    ds_read_b128 v[200:203], v125 offset:36864
    v_mfma_f32_16x16x32_bf16 v[56:59], v[152:155], v[172:175], v[56:59]
    s_cselect_b32 s71, s70, s71
    ds_read_b128 v[204:207], v125 offset:38912
    v_mfma_f32_16x16x32_bf16 v[60:63], v[156:159], v[172:175], v[60:63]
    s_waitcnt lgkmcnt(6)
    s_add_u32 s67, s67, 1
    v_mfma_f32_16x16x32_bf16 v[0:3], v[176:179], v[192:195], v[0:3]
    s_waitcnt vmcnt(7)
    s_barrier
    ds_read_b64_tr_b16 v[144:145], v120 offset:49152
    v_mfma_f32_16x16x32_bf16 v[4:7], v[180:183], v[192:195], v[4:7]
    ds_read_b64_tr_b16 v[146:147], v120 offset:50176
    v_mfma_f32_16x16x32_bf16 v[16:19], v[176:179], v[196:199], v[16:19]
    ds_read_b128 v[160:163], v124 offset:49152
    v_mfma_f32_16x16x32_bf16 v[20:23], v[180:183], v[196:199], v[20:23]
    s_waitcnt lgkmcnt(5)
    v_mfma_f32_16x16x32_bf16 v[8:11], v[184:187], v[192:195], v[8:11]
    ds_read_b64_tr_b16 v[148:149], v121 offset:49152
    v_mfma_f32_16x16x32_bf16 v[12:15], v[188:191], v[192:195], v[12:15]
    ds_read_b64_tr_b16 v[150:151], v121 offset:50176
    v_mfma_f32_16x16x32_bf16 v[24:27], v[184:187], v[196:199], v[24:27]
    ds_read_b128 v[164:167], v124 offset:51200
    v_mfma_f32_16x16x32_bf16 v[28:31], v[188:191], v[196:199], v[28:31]
    s_waitcnt lgkmcnt(6)
    v_mfma_f32_16x16x32_bf16 v[32:35], v[176:179], v[200:203], v[32:35]
    ds_read_b64_tr_b16 v[152:153], v122 offset:49152
    v_mfma_f32_16x16x32_bf16 v[36:39], v[180:183], v[200:203], v[36:39]
    ds_read_b64_tr_b16 v[154:155], v122 offset:50176
    v_mfma_f32_16x16x32_bf16 v[40:43], v[184:187], v[200:203], v[40:43]
    ds_read_b64_tr_b16 v[156:157], v123 offset:49152
    v_mfma_f32_16x16x32_bf16 v[44:47], v[188:191], v[200:203], v[44:47]
    v_mfma_f32_16x16x32_bf16 v[48:51], v[176:179], v[204:207], v[48:51]
    ds_read_b64_tr_b16 v[158:159], v123 offset:50176
    v_mfma_f32_16x16x32_bf16 v[52:55], v[180:183], v[204:207], v[52:55]
    ds_read_b128 v[168:171], v124 offset:53248
    v_mfma_f32_16x16x32_bf16 v[56:59], v[184:187], v[204:207], v[56:59]
    ds_read_b128 v[172:175], v124 offset:55296
    v_mfma_f32_16x16x32_bf16 v[60:63], v[188:191], v[204:207], v[60:63]
    s_waitcnt lgkmcnt(6)
    v_mfma_f32_16x16x32_bf16 v[0:3], v[144:147], v[160:163], v[0:3]
    ds_read_b64_tr_b16 v[176:177], v120 offset:57344
    v_mfma_f32_16x16x32_bf16 v[4:7], v[148:151], v[160:163], v[4:7]
    ds_read_b64_tr_b16 v[178:179], v120 offset:58368
    v_mfma_f32_16x16x32_bf16 v[16:19], v[144:147], v[164:167], v[16:19]
    ds_read_b128 v[192:195], v125 offset:49152
    v_mfma_f32_16x16x32_bf16 v[20:23], v[148:151], v[164:167], v[20:23]
    s_waitcnt lgkmcnt(5)
    v_mfma_f32_16x16x32_bf16 v[8:11], v[152:155], v[160:163], v[8:11]
    ds_read_b64_tr_b16 v[180:181], v121 offset:57344
    v_mfma_f32_16x16x32_bf16 v[12:15], v[156:159], v[160:163], v[12:15]
    ds_read_b64_tr_b16 v[182:183], v121 offset:58368
    v_mfma_f32_16x16x32_bf16 v[24:27], v[152:155], v[164:167], v[24:27]
    ds_read_b128 v[196:199], v125 offset:51200
    v_mfma_f32_16x16x32_bf16 v[28:31], v[156:159], v[164:167], v[28:31]
    s_waitcnt lgkmcnt(6)
    v_mfma_f32_16x16x32_bf16 v[32:35], v[144:147], v[168:171], v[32:35]
    ds_read_b64_tr_b16 v[184:185], v122 offset:57344
    v_mfma_f32_16x16x32_bf16 v[36:39], v[148:151], v[168:171], v[36:39]
    ds_read_b64_tr_b16 v[186:187], v122 offset:58368
    v_mfma_f32_16x16x32_bf16 v[40:43], v[152:155], v[168:171], v[40:43]
    ds_read_b64_tr_b16 v[188:189], v123 offset:57344
    v_mfma_f32_16x16x32_bf16 v[44:47], v[156:159], v[168:171], v[44:47]
    v_mfma_f32_16x16x32_bf16 v[48:51], v[144:147], v[172:175], v[48:51]
    ds_read_b64_tr_b16 v[190:191], v123 offset:58368
    v_mfma_f32_16x16x32_bf16 v[52:55], v[148:151], v[172:175], v[52:55]
    ds_read_b128 v[200:203], v125 offset:53248
    v_mfma_f32_16x16x32_bf16 v[56:59], v[152:155], v[172:175], v[56:59]
    ds_read_b128 v[204:207], v125 offset:55296
    v_mfma_f32_16x16x32_bf16 v[60:63], v[156:159], v[172:175], v[60:63]
    s_waitcnt lgkmcnt(6)
    v_mfma_f32_16x16x32_bf16 v[0:3], v[176:179], v[192:195], v[0:3]
    s_mov_b32 s62, 0x3e0293ee
    s_lshr_b32 s63, s52, 1
    v_mfma_f32_16x16x32_bf16 v[4:7], v[180:183], v[192:195], v[4:7]
    s_lshl_b32 s65, s5, 1
    s_add_u32 s65, s65, s63
    v_mfma_f32_16x16x32_bf16 v[16:19], v[176:179], v[196:199], v[16:19]
    s_lshl_b32 s10, s65, 7
    s_add_u32 s10, s10, s54
    v_mfma_f32_16x16x32_bf16 v[20:23], v[180:183], v[196:199], v[20:23]
    s_waitcnt lgkmcnt(2)
    s_lshl_b32 s10, s10, 12
    s_and_b32 s63, s52, 1
    v_mfma_f32_16x16x32_bf16 v[8:11], v[184:187], v[192:195], v[8:11]
    s_lshl_b32 s12, s63, 11
    s_add_u32 s10, s10, s12
    v_mfma_f32_16x16x32_bf16 v[12:15], v[188:191], v[192:195], v[12:15]
    s_add_u32 s11, s10, 131072
    s_add_u32 s13, s10, 262144
    v_mfma_f32_16x16x32_bf16 v[24:27], v[184:187], v[196:199], v[24:27]
    s_add_u32 s14, s10, 393216
    s_lshl_b32 s64, s65, 4
    v_mfma_f32_16x16x32_bf16 v[28:31], v[188:191], v[196:199], v[28:31]
    s_waitcnt lgkmcnt(0)
    s_lshr_b32 s12, s54, 1
    s_add_u32 s64, s64, s12
    v_mfma_f32_16x16x32_bf16 v[32:35], v[176:179], v[200:203], v[32:35]
    s_lshl_b32 s64, s64, 7
    s_and_b32 s12, s54, 1
    v_mfma_f32_16x16x32_bf16 v[36:39], v[180:183], v[200:203], v[36:39]
    s_lshl_b32 s12, s12, 1
    s_add_u32 s12, s12, s63
    v_mfma_f32_16x16x32_bf16 v[40:43], v[184:187], v[200:203], v[40:43]
    s_lshl_b32 s12, s12, 2
    s_add_u32 s64, s64, s12
    v_mfma_f32_16x16x32_bf16 v[44:47], v[188:191], v[200:203], v[44:47]
    s_add_u32 s64, s64, 0x2000000
    v_mfma_f32_16x16x32_bf16 v[48:51], v[176:179], v[204:207], v[48:51]
    v_mfma_f32_16x16x32_bf16 v[52:55], v[180:183], v[204:207], v[52:55]
    v_mfma_f32_16x16x32_bf16 v[56:59], v[184:187], v[204:207], v[56:59]
    v_mfma_f32_16x16x32_bf16 v[60:63], v[188:191], v[204:207], v[60:63]
    s_nop 3
    v_mul_f32 v0, s62, v0
    v_mul_f32 v1, s62, v1
    v_mul_f32 v2, s62, v2
    v_mul_f32 v3, s62, v3
    v_mul_f32 v4, s62, v4
    v_mul_f32 v5, s62, v5
    v_mul_f32 v6, s62, v6
    v_mul_f32 v7, s62, v7
    v_cvt_pk_bf16_f32 v64, v0, v1
    v_cvt_pk_bf16_f32 v66, v4, v5
    v_cvt_pk_bf16_f32 v65, v2, v3
    v_cvt_pk_bf16_f32 v67, v6, v7
    v_permlane16_swap_b32 v64, v66
    s_nop 0
    v_permlane16_swap_b32 v65, v67
    buffer_store_dwordx4 v[64:67], v128, s[44:47], s10 offen offset:0 sc1
    v_mul_f32 v8, s62, v8
    v_mul_f32 v9, s62, v9
    v_mul_f32 v10, s62, v10
    v_mul_f32 v11, s62, v11
    v_mul_f32 v12, s62, v12
    v_mul_f32 v13, s62, v13
    v_mul_f32 v14, s62, v14
    v_mul_f32 v15, s62, v15
    v_cvt_pk_bf16_f32 v68, v8, v9
    v_cvt_pk_bf16_f32 v70, v12, v13
    v_cvt_pk_bf16_f32 v69, v10, v11
    v_cvt_pk_bf16_f32 v71, v14, v15
    v_permlane16_swap_b32 v68, v70
    s_nop 0
    v_permlane16_swap_b32 v69, v71
    buffer_store_dwordx4 v[68:71], v128, s[44:47], s10 offen offset:1024 sc1
    v_mul_f32 v16, s62, v16
    v_mul_f32 v17, s62, v17
    v_mul_f32 v18, s62, v18
    v_mul_f32 v19, s62, v19
    v_mul_f32 v20, s62, v20
    v_mul_f32 v21, s62, v21
    v_mul_f32 v22, s62, v22
    v_mul_f32 v23, s62, v23
    v_cvt_pk_bf16_f32 v72, v16, v17
    v_cvt_pk_bf16_f32 v74, v20, v21
    v_cvt_pk_bf16_f32 v73, v18, v19
    v_cvt_pk_bf16_f32 v75, v22, v23
    v_permlane16_swap_b32 v72, v74
    s_nop 0
    v_permlane16_swap_b32 v73, v75
    buffer_store_dwordx4 v[72:75], v128, s[44:47], s11 offen offset:0 sc1
    v_mul_f32 v24, s62, v24
    v_mul_f32 v25, s62, v25
    v_mul_f32 v26, s62, v26
    v_mul_f32 v27, s62, v27
    v_mul_f32 v28, s62, v28
    v_mul_f32 v29, s62, v29
    v_mul_f32 v30, s62, v30
    v_mul_f32 v31, s62, v31
    v_cvt_pk_bf16_f32 v76, v24, v25
    v_cvt_pk_bf16_f32 v78, v28, v29
    v_cvt_pk_bf16_f32 v77, v26, v27
    v_cvt_pk_bf16_f32 v79, v30, v31
    v_permlane16_swap_b32 v76, v78
    s_nop 0
    v_permlane16_swap_b32 v77, v79
    buffer_store_dwordx4 v[76:79], v128, s[44:47], s11 offen offset:1024 sc1
    v_mul_f32 v32, s62, v32
    v_mul_f32 v33, s62, v33
    v_mul_f32 v34, s62, v34
    v_mul_f32 v35, s62, v35
    v_mul_f32 v36, s62, v36
    v_mul_f32 v37, s62, v37
    v_mul_f32 v38, s62, v38
    v_mul_f32 v39, s62, v39
    v_cvt_pk_bf16_f32 v80, v32, v33
    v_cvt_pk_bf16_f32 v82, v36, v37
    v_cvt_pk_bf16_f32 v81, v34, v35
    v_cvt_pk_bf16_f32 v83, v38, v39
    v_permlane16_swap_b32 v80, v82
    s_nop 0
    v_permlane16_swap_b32 v81, v83
    buffer_store_dwordx4 v[80:83], v128, s[44:47], s13 offen offset:0 sc1
    v_mul_f32 v40, s62, v40
    v_mul_f32 v41, s62, v41
    v_mul_f32 v42, s62, v42
    v_mul_f32 v43, s62, v43
    v_mul_f32 v44, s62, v44
    v_mul_f32 v45, s62, v45
    v_mul_f32 v46, s62, v46
    v_mul_f32 v47, s62, v47
    v_cvt_pk_bf16_f32 v84, v40, v41
    v_cvt_pk_bf16_f32 v86, v44, v45
    v_cvt_pk_bf16_f32 v85, v42, v43
    v_cvt_pk_bf16_f32 v87, v46, v47
    v_permlane16_swap_b32 v84, v86
    s_nop 0
    v_permlane16_swap_b32 v85, v87
    buffer_store_dwordx4 v[84:87], v128, s[44:47], s13 offen offset:1024 sc1
    v_mul_f32 v48, s62, v48
    v_mul_f32 v49, s62, v49
    v_mul_f32 v50, s62, v50
    v_mul_f32 v51, s62, v51
    v_mul_f32 v52, s62, v52
    v_mul_f32 v53, s62, v53
    v_mul_f32 v54, s62, v54
    v_mul_f32 v55, s62, v55
    v_cvt_pk_bf16_f32 v88, v48, v49
    v_cvt_pk_bf16_f32 v90, v52, v53
    v_cvt_pk_bf16_f32 v89, v50, v51
    v_cvt_pk_bf16_f32 v91, v54, v55
    v_permlane16_swap_b32 v88, v90
    s_nop 0
    v_permlane16_swap_b32 v89, v91
    buffer_store_dwordx4 v[88:91], v128, s[44:47], s14 offen offset:0 sc1
    v_mul_f32 v56, s62, v56
    v_mul_f32 v57, s62, v57
    v_mul_f32 v58, s62, v58
    v_mul_f32 v59, s62, v59
    v_mul_f32 v60, s62, v60
    v_mul_f32 v61, s62, v61
    v_mul_f32 v62, s62, v62
    v_mul_f32 v63, s62, v63
    v_cvt_pk_bf16_f32 v92, v56, v57
    v_cvt_pk_bf16_f32 v94, v60, v61
    v_cvt_pk_bf16_f32 v93, v58, v59
    v_cvt_pk_bf16_f32 v95, v62, v63
    v_permlane16_swap_b32 v92, v94
    s_nop 0
    v_permlane16_swap_b32 v93, v95
    buffer_store_dwordx4 v[92:95], v128, s[44:47], s14 offen offset:1024 sc1
    s_barrier
    s_mov_b32 m0, s70
    s_mov_b32 s6, 0
    buffer_load_dwordx4 v249, s[36:39], s6 offen lds
    s_mov_b32 s6, 8192
    buffer_load_dwordx4 v249, s[36:39], s6 offen lds
    s_mov_b32 s6, 16384
    buffer_load_dwordx4 v249, s[36:39], s6 offen lds
    s_mov_b32 s6, 24576
    buffer_load_dwordx4 v249, s[36:39], s6 offen lds
    s_waitcnt vmcnt(18)
    v_readfirstlane_b32 s59, v108
    s_mov_b32 s73, 0
    s_cmp_lg_u32 s59, 0
    s_cbranch_scc1 L_have_nonce0
L_nonce_spin0:
    v_mov_b32 v108, 0
    buffer_load_dword v108, v108, s[48:51], 0 offen sc1
    s_waitcnt vmcnt(0)
    v_readfirstlane_b32 s59, v108
    s_add_u32 s73, s73, 1
    s_cmp_gt_u32 s73, 200000
    s_cbranch_scc1 L_have_nonce0
    s_cmp_eq_u32 s59, 0
    s_cbranch_scc1 L_nonce_spin0
L_have_nonce0:
    v_mov_b32 v0, 0
    v_mov_b32 v1, 0
    v_mov_b32 v2, 0
    v_mov_b32 v3, 0
    v_mov_b32 v4, 0
    v_mov_b32 v5, 0
    v_mov_b32 v6, 0
    v_mov_b32 v7, 0
    v_mov_b32 v8, 0
    v_mov_b32 v9, 0
    v_mov_b32 v10, 0
    v_mov_b32 v11, 0
    v_mov_b32 v12, 0
    v_mov_b32 v13, 0
    v_mov_b32 v14, 0
    v_mov_b32 v15, 0
    v_mov_b32 v16, 0
    v_mov_b32 v17, 0
    v_mov_b32 v18, 0
    v_mov_b32 v19, 0
    v_mov_b32 v20, 0
    v_mov_b32 v21, 0
    v_mov_b32 v22, 0
    v_mov_b32 v23, 0
    v_mov_b32 v24, 0
    v_mov_b32 v25, 0
    v_mov_b32 v26, 0
    v_mov_b32 v27, 0
    v_mov_b32 v28, 0
    v_mov_b32 v29, 0
    v_mov_b32 v30, 0
    v_mov_b32 v31, 0
    v_mov_b32 v32, 0
    v_mov_b32 v33, 0
    v_mov_b32 v34, 0
    v_mov_b32 v35, 0
    v_mov_b32 v36, 0
    v_mov_b32 v37, 0
    v_mov_b32 v38, 0
    v_mov_b32 v39, 0
    v_mov_b32 v40, 0
    v_mov_b32 v41, 0
    v_mov_b32 v42, 0
    v_mov_b32 v43, 0
    v_mov_b32 v44, 0
    v_mov_b32 v45, 0
    v_mov_b32 v46, 0
    v_mov_b32 v47, 0
    v_mov_b32 v48, 0
    v_mov_b32 v49, 0
    v_mov_b32 v50, 0
    v_mov_b32 v51, 0
    v_mov_b32 v52, 0
    v_mov_b32 v53, 0
    v_mov_b32 v54, 0
    v_mov_b32 v55, 0
    v_mov_b32 v56, 0
    v_mov_b32 v57, 0
    v_mov_b32 v58, 0
    v_mov_b32 v59, 0
    v_mov_b32 v60, 0
    v_mov_b32 v61, 0
    v_mov_b32 v62, 0
    v_mov_b32 v63, 0
    v_mov_b32 v176, 0
    v_mov_b32 v177, 0
    v_mov_b32 v178, 0
    v_mov_b32 v179, 0
    v_mov_b32 v180, 0
    v_mov_b32 v181, 0
    v_mov_b32 v182, 0
    v_mov_b32 v183, 0
    v_mov_b32 v184, 0
    v_mov_b32 v185, 0
    v_mov_b32 v186, 0
    v_mov_b32 v187, 0
    v_mov_b32 v188, 0
    v_mov_b32 v189, 0
    v_mov_b32 v190, 0
    v_mov_b32 v191, 0
    v_mov_b32 v192, 0
    v_mov_b32 v193, 0
    v_mov_b32 v194, 0
    v_mov_b32 v195, 0
    v_mov_b32 v196, 0
    v_mov_b32 v197, 0
    v_mov_b32 v198, 0
    v_mov_b32 v199, 0
    v_mov_b32 v200, 0
    v_mov_b32 v201, 0
    v_mov_b32 v202, 0
    v_mov_b32 v203, 0
    v_mov_b32 v204, 0
    v_mov_b32 v205, 0
    v_mov_b32 v206, 0
    v_mov_b32 v207, 0
    v_mov_b32 v216, 0
    v_mov_b32 v217, 0
    v_mov_b32 v218, 0
    v_mov_b32 v219, 0
    v_mov_b32 v220, 0
    v_mov_b32 v221, 0
    v_mov_b32 v222, 0
    v_mov_b32 v223, 0
    v_mov_b32 v240, 0
    v_mov_b32 v241, 0
    v_mov_b32 v242, 0
    v_mov_b32 v243, 0
    v_mov_b32 v244, 0
    v_mov_b32 v245, 0
    v_mov_b32 v246, 0
    v_mov_b32 v247, 0
    v_mov_b32 v104, 0x3f803f80
    v_mov_b32 v105, 0x3f803f80
    v_mov_b32 v106, 0x3f803f80
    v_mov_b32 v107, 0x3f803f80
    v_mov_b32 v234, v232
    s_lshl_b32 s9, s57, 2
    s_add_u32 s9, s9, s55
    s_lshl_b32 s9, s9, 2
    s_add_u32 s9, s9, s52
    s_lshl_b32 s10, s9, 13
    s_add_u32 s10, s10, 0x800000
    s_add_u32 s11, s10, 4096
    s_lshl_b32 s12, s9, 10
    s_add_u32 s12, s12, 0xc00000
    s_lshl_b32 s13, s9, 7
    s_add_u32 s13, s13, 0x2008000
    s_add_u32 s14, s8, 4096
    s_waitcnt vmcnt(4)
    v_mov_b32 v250, s59
    v_mov_b32 v251, 0
    s_mov_b64 exec, 1
    buffer_store_dword v250, v251, s[44:47], s64 offen sc1
    s_mov_b64 exec, -1
    s_mov_b32 s6, 32768
    buffer_load_dwordx4 v249, s[36:39], s6 offen lds
    s_mov_b32 s6, 40960
    buffer_load_dwordx4 v249, s[36:39], s6 offen lds
    s_mov_b32 s6, 49152
    buffer_load_dwordx4 v249, s[36:39], s6 offen lds
    s_mov_b32 s6, 57344
    buffer_load_dwordx4 v249, s[36:39], s6 offen lds
    s_mov_b32 s73, 0
L_poll_q:
    s_buffer_load_dwordx4 s[32:35], s[44:47], s18 glc
    s_add_u32 s73, s73, 1
    s_cmp_gt_u32 s73, 200000
    s_waitcnt lgkmcnt(0)
    s_cbranch_scc1 L_polled_q
    s_xor_b32 s32, s32, s59
    s_xor_b32 s33, s33, s59
    s_xor_b32 s34, s34, s59
    s_xor_b32 s35, s35, s59
    s_or_b64 s[32:33], s[32:33], s[34:35]
    s_cmp_eq_u64 s[32:33], 0
    s_cbranch_scc1 L_polled_q
    s_cmp_ge_u32 s67, 1
    s_cbranch_scc1 L_poll_q
    s_waitcnt vmcnt(4)
    s_mov_b32 m0, s71
    s_add_u32 s71, s71, 16640
    buffer_load_dwordx4 v236, s[24:27], s66 offen offset:2080 nt lds
    buffer_load_dwordx4 v237, s[24:27], s66 offen offset:3136 nt lds
    buffer_load_dwordx4 v238, s[28:31], s66 offen nt lds
    buffer_load_dwordx4 v239, s[28:31], s66 offen offset:1056 nt lds
    s_add_u32 s66, s66, 8192
    s_cmp_eq_u32 s71, s76
    s_cselect_b32 s71, s70, s71
    s_add_u32 s67, s67, 1
    s_branch L_poll_q
L_polled_q:
    buffer_load_dwordx4 v[112:115], v248, s[44:47], s8 offen offset:0 sc1
    buffer_load_dwordx4 v[116:119], v248, s[44:47], s8 offen offset:1024 sc1
    buffer_load_dwordx4 v[120:123], v248, s[44:47], s8 offen offset:2048 sc1
    buffer_load_dwordx4 v[124:127], v248, s[44:47], s8 offen offset:3072 sc1
    buffer_load_dwordx4 v[128:131], v248, s[44:47], s14 offen offset:0 sc1
    buffer_load_dwordx4 v[132:135], v248, s[44:47], s14 offen offset:1024 sc1
    buffer_load_dwordx4 v[136:139], v248, s[44:47], s14 offen offset:2048 sc1
    buffer_load_dwordx4 v[140:143], v248, s[44:47], s14 offen offset:3072 sc1
    s_mov_b32 m0, s71
    s_add_u32 s71, s71, 16640
    buffer_load_dwordx4 v236, s[24:27], s66 offen offset:2080 nt lds
    buffer_load_dwordx4 v237, s[24:27], s66 offen offset:3136 nt lds
    buffer_load_dwordx4 v238, s[28:31], s66 offen nt lds
    buffer_load_dwordx4 v239, s[28:31], s66 offen offset:1056 nt lds
    s_add_u32 s66, s66, 8192
    s_cmp_eq_u32 s71, s76
    s_cselect_b32 s71, s70, s71
    s_add_u32 s67, s67, 1
    s_mov_b32 m0, s71
    s_add_u32 s71, s71, 16640
    buffer_load_dwordx4 v236, s[24:27], s66 offen offset:2080 nt lds
    buffer_load_dwordx4 v237, s[24:27], s66 offen offset:3136 nt lds
    buffer_load_dwordx4 v238, s[28:31], s66 offen nt lds
    buffer_load_dwordx4 v239, s[28:31], s66 offen offset:1056 nt lds
    s_add_u32 s66, s66, 8192
    s_cmp_eq_u32 s71, s76
    s_cselect_b32 s71, s70, s71
    s_add_u32 s67, s67, 1
    s_waitcnt vmcnt(8)
    s_barrier
    ds_read_b128 v[144:147], v234 offset:0
    ds_read_b128 v[148:151], v234 offset:512
    ds_read_b128 v[152:155], v234 offset:64
    ds_read_b128 v[156:159], v234 offset:576
    ds_read_b128 v[160:163], v234 offset:128
    ds_read_b128 v[164:167], v234 offset:640
    ds_read_b128 v[168:171], v234 offset:192
    ds_read_b128 v[172:175], v234 offset:704
    s_branch L_q_landed
L_role_a:
    v_mov_b32 v0, 0
    v_mov_b32 v1, 0
    v_mov_b32 v2, 0
    v_mov_b32 v3, 0
    v_mov_b32 v4, 0
    v_mov_b32 v5, 0
    v_mov_b32 v6, 0
    v_mov_b32 v7, 0
    v_mov_b32 v8, 0
    v_mov_b32 v9, 0
    v_mov_b32 v10, 0
    v_mov_b32 v11, 0
    v_mov_b32 v12, 0
    v_mov_b32 v13, 0
    v_mov_b32 v14, 0
    v_mov_b32 v15, 0
    v_mov_b32 v16, 0
    v_mov_b32 v17, 0
    v_mov_b32 v18, 0
    v_mov_b32 v19, 0
    v_mov_b32 v20, 0
    v_mov_b32 v21, 0
    v_mov_b32 v22, 0
    v_mov_b32 v23, 0
    v_mov_b32 v24, 0
    v_mov_b32 v25, 0
    v_mov_b32 v26, 0
    v_mov_b32 v27, 0
    v_mov_b32 v28, 0
    v_mov_b32 v29, 0
    v_mov_b32 v30, 0
    v_mov_b32 v31, 0
    v_mov_b32 v32, 0
    v_mov_b32 v33, 0
    v_mov_b32 v34, 0
    v_mov_b32 v35, 0
    v_mov_b32 v36, 0
    v_mov_b32 v37, 0
    v_mov_b32 v38, 0
    v_mov_b32 v39, 0
    v_mov_b32 v40, 0
    v_mov_b32 v41, 0
    v_mov_b32 v42, 0
    v_mov_b32 v43, 0
    v_mov_b32 v44, 0
    v_mov_b32 v45, 0
    v_mov_b32 v46, 0
    v_mov_b32 v47, 0
    v_mov_b32 v48, 0
    v_mov_b32 v49, 0
    v_mov_b32 v50, 0
    v_mov_b32 v51, 0
    v_mov_b32 v52, 0
    v_mov_b32 v53, 0
    v_mov_b32 v54, 0
    v_mov_b32 v55, 0
    v_mov_b32 v56, 0
    v_mov_b32 v57, 0
    v_mov_b32 v58, 0
    v_mov_b32 v59, 0
    v_mov_b32 v60, 0
    v_mov_b32 v61, 0
    v_mov_b32 v62, 0
    v_mov_b32 v63, 0
    v_mov_b32 v176, 0
    v_mov_b32 v177, 0
    v_mov_b32 v178, 0
    v_mov_b32 v179, 0
    v_mov_b32 v180, 0
    v_mov_b32 v181, 0
    v_mov_b32 v182, 0
    v_mov_b32 v183, 0
    v_mov_b32 v184, 0
    v_mov_b32 v185, 0
    v_mov_b32 v186, 0
    v_mov_b32 v187, 0
    v_mov_b32 v188, 0
    v_mov_b32 v189, 0
    v_mov_b32 v190, 0
    v_mov_b32 v191, 0
    v_mov_b32 v192, 0
    v_mov_b32 v193, 0
    v_mov_b32 v194, 0
    v_mov_b32 v195, 0
    v_mov_b32 v196, 0
    v_mov_b32 v197, 0
    v_mov_b32 v198, 0
    v_mov_b32 v199, 0
    v_mov_b32 v200, 0
    v_mov_b32 v201, 0
    v_mov_b32 v202, 0
    v_mov_b32 v203, 0
    v_mov_b32 v204, 0
    v_mov_b32 v205, 0
    v_mov_b32 v206, 0
    v_mov_b32 v207, 0
    v_mov_b32 v216, 0
    v_mov_b32 v217, 0
    v_mov_b32 v218, 0
    v_mov_b32 v219, 0
    v_mov_b32 v220, 0
    v_mov_b32 v221, 0
    v_mov_b32 v222, 0
    v_mov_b32 v223, 0
    v_mov_b32 v240, 0
    v_mov_b32 v241, 0
    v_mov_b32 v242, 0
    v_mov_b32 v243, 0
    v_mov_b32 v244, 0
    v_mov_b32 v245, 0
    v_mov_b32 v246, 0
    v_mov_b32 v247, 0
    v_mov_b32 v104, 0x3f803f80
    v_mov_b32 v105, 0x3f803f80
    v_mov_b32 v106, 0x3f803f80
    v_mov_b32 v107, 0x3f803f80
    v_mov_b32 v234, v232
    s_lshl_b32 s9, s57, 2
    s_add_u32 s9, s9, s55
    s_lshl_b32 s9, s9, 2
    s_add_u32 s9, s9, s52
    s_lshl_b32 s10, s9, 13
    s_add_u32 s10, s10, 0x800000
    s_add_u32 s11, s10, 4096
    s_lshl_b32 s12, s9, 10
    s_add_u32 s12, s12, 0xc00000
    s_lshl_b32 s13, s9, 7
    s_add_u32 s13, s13, 0x2008000
    s_add_u32 s14, s8, 4096
    s_mov_b32 s6, 3145728
    buffer_load_dwordx4 v130, s[32:35], s6 offen lds
    s_mov_b32 s6, 768
    buffer_load_dwordx4 v131, s[20:23], s6 offen lds
    s_mov_b32 s6, 3670016
    buffer_load_dwordx4 v130, s[32:35], s6 offen lds
    s_mov_b32 s6, 896
    buffer_load_dwordx4 v131, s[20:23], s6 offen lds
    s_mov_b32 s6, 4194304
    buffer_load_dwordx4 v130, s[32:35], s6 offen lds
    s_mov_b32 s6, 1024
    buffer_load_dwordx4 v131, s[20:23], s6 offen lds
    s_mov_b32 s6, 4718592
    buffer_load_dwordx4 v130, s[32:35], s6 offen lds
    s_mov_b32 s6, 1152
    buffer_load_dwordx4 v131, s[20:23], s6 offen lds
    s_mov_b32 s6, 5242880
    buffer_load_dwordx4 v130, s[32:35], s6 offen lds
    s_mov_b32 s6, 1280
    buffer_load_dwordx4 v131, s[20:23], s6 offen lds
    s_mov_b32 s6, 5767168
    buffer_load_dwordx4 v130, s[32:35], s6 offen lds
    s_mov_b32 s6, 1408
    buffer_load_dwordx4 v131, s[20:23], s6 offen lds
    s_mov_b32 s6, 6291456
    buffer_load_dwordx4 v130, s[32:35], s6 offen lds
    s_mov_b32 s6, 1536
    buffer_load_dwordx4 v131, s[20:23], s6 offen lds
    s_mov_b32 s6, 6815744
    buffer_load_dwordx4 v130, s[32:35], s6 offen lds
    s_mov_b32 s6, 1664
    buffer_load_dwordx4 v131, s[20:23], s6 offen lds
    s_mov_b32 s6, 7340032
    buffer_load_dwordx4 v130, s[32:35], s6 offen lds
    s_mov_b32 s6, 1792
    buffer_load_dwordx4 v131, s[20:23], s6 offen lds
    s_mov_b32 s6, 7864320
    buffer_load_dwordx4 v130, s[32:35], s6 offen lds
    s_mov_b32 s6, 1920
    buffer_load_dwordx4 v131, s[20:23], s6 offen lds
    s_add_u32 m0, s70, 2080
    s_nop 0
    buffer_load_dwordx4 v238, s[24:27], s66 offen nt lds
    buffer_load_dwordx4 v239, s[24:27], s66 offen offset:1056 nt lds
    s_mov_b32 m0, s71
    s_add_u32 s71, s71, 16640
    buffer_load_dwordx4 v236, s[24:27], s66 offen offset:2080 nt lds
    buffer_load_dwordx4 v237, s[24:27], s66 offen offset:3136 nt lds
    buffer_load_dwordx4 v238, s[28:31], s66 offen nt lds
    buffer_load_dwordx4 v239, s[28:31], s66 offen offset:1056 nt lds
    s_add_u32 s66, s66, 8192
    s_cmp_eq_u32 s71, s76
    s_cselect_b32 s71, s70, s71
    s_add_u32 s67, s67, 1
    s_mov_b32 m0, s71
    s_add_u32 s71, s71, 16640
    buffer_load_dwordx4 v236, s[24:27], s66 offen offset:2080 nt lds
    buffer_load_dwordx4 v237, s[24:27], s66 offen offset:3136 nt lds
    buffer_load_dwordx4 v238, s[28:31], s66 offen nt lds
    buffer_load_dwordx4 v239, s[28:31], s66 offen offset:1056 nt lds
    s_add_u32 s66, s66, 8192
    s_cmp_eq_u32 s71, s76
    s_cselect_b32 s71, s70, s71
    s_add_u32 s67, s67, 1
    s_mov_b32 m0, s71
    s_add_u32 s71, s71, 16640
    buffer_load_dwordx4 v236, s[24:27], s66 offen offset:2080 nt lds
    buffer_load_dwordx4 v237, s[24:27], s66 offen offset:3136 nt lds
    buffer_load_dwordx4 v238, s[28:31], s66 offen nt lds
    buffer_load_dwordx4 v239, s[28:31], s66 offen offset:1056 nt lds
    s_add_u32 s66, s66, 8192
    s_cmp_eq_u32 s71, s76
    s_cselect_b32 s71, s70, s71
    s_add_u32 s67, s67, 1
    s_mov_b32 m0, s71
    s_add_u32 s71, s71, 16640
    buffer_load_dwordx4 v236, s[24:27], s66 offen offset:2080 nt lds
    buffer_load_dwordx4 v237, s[24:27], s66 offen offset:3136 nt lds
    buffer_load_dwordx4 v238, s[28:31], s66 offen nt lds
    buffer_load_dwordx4 v239, s[28:31], s66 offen offset:1056 nt lds
    s_add_u32 s66, s66, 8192
    s_cmp_eq_u32 s71, s76
    s_cselect_b32 s71, s70, s71
    s_add_u32 s67, s67, 1
    s_mov_b32 m0, s71
    s_add_u32 s71, s71, 16640
    buffer_load_dwordx4 v236, s[24:27], s66 offen offset:2080 nt lds
    buffer_load_dwordx4 v237, s[24:27], s66 offen offset:3136 nt lds
    buffer_load_dwordx4 v238, s[28:31], s66 offen nt lds
    buffer_load_dwordx4 v239, s[28:31], s66 offen offset:1056 nt lds
    s_add_u32 s66, s66, 8192
    s_cmp_eq_u32 s71, s76
    s_cselect_b32 s71, s70, s71
    s_add_u32 s67, s67, 1
    buffer_load_dwordx4 v[64:67], v236, s[24:27], s66 offen offset:2080 nt
    buffer_load_dwordx4 v[68:71], v237, s[24:27], s66 offen offset:3136 nt
    buffer_load_dwordx4 v[72:75], v238, s[28:31], s66 offen nt
    buffer_load_dwordx4 v[76:79], v239, s[28:31], s66 offen offset:1056 nt
    s_add_u32 s66, s66, 8192
    buffer_load_dwordx4 v[80:83], v236, s[24:27], s66 offen offset:2080 nt
    buffer_load_dwordx4 v[84:87], v237, s[24:27], s66 offen offset:3136 nt
    buffer_load_dwordx4 v[88:91], v238, s[28:31], s66 offen nt
    buffer_load_dwordx4 v[92:95], v239, s[28:31], s66 offen offset:1056 nt
    s_add_u32 s66, s66, 8192
    buffer_load_dwordx4 v[96:99], v236, s[24:27], s66 offen offset:2080 nt
    buffer_load_dwordx4 v[100:103], v237, s[24:27], s66 offen offset:3136 nt
    buffer_load_dwordx4 v[224:227], v238, s[28:31], s66 offen nt
    buffer_load_dwordx4 v[228:231], v239, s[28:31], s66 offen offset:1056 nt
    s_add_u32 s66, s66, 8192
    v_mov_b32 v108, 0
    buffer_load_dword v108, v108, s[48:51], 0 offen sc1
    v_add_u32 v235, s71, v248
    s_mov_b32 s71, s70
    s_add_u32 s67, s67, 3
    s_add_u32 m0, s75, 0
    s_and_b32 s17, s17, 0x1fffff
    buffer_load_dwordx4 v109, s[36:39], s17 offen lds
    s_add_u32 s17, s17, 32768
    s_add_u32 m0, s75, 1024
    s_and_b32 s17, s17, 0x1fffff
    buffer_load_dwordx4 v109, s[36:39], s17 offen lds
    s_add_u32 s17, s17, 32768
    s_add_u32 m0, s75, 2048
    s_and_b32 s17, s17, 0x1fffff
    buffer_load_dwordx4 v109, s[36:39], s17 offen lds
    s_add_u32 s17, s17, 32768
    s_add_u32 m0, s75, 3072
    s_and_b32 s17, s17, 0x1fffff
    buffer_load_dwordx4 v109, s[36:39], s17 offen lds
    s_add_u32 s17, s17, 32768
    s_call_b64 s[60:61], L_wo_main
    v_readfirstlane_b32 s59, v108
    s_mov_b32 s73, 0
    s_cmp_lg_u32 s59, 0
    s_cbranch_scc1 L_have_nonce1
L_nonce_spin1:
    v_mov_b32 v108, 0
    buffer_load_dword v108, v108, s[48:51], 0 offen sc1
    s_waitcnt vmcnt(0)
    v_readfirstlane_b32 s59, v108
    s_add_u32 s73, s73, 1
    s_cmp_gt_u32 s73, 200000
    s_cbranch_scc1 L_have_nonce1
    s_cmp_eq_u32 s59, 0
    s_cbranch_scc1 L_nonce_spin1
L_have_nonce1:
    s_mov_b32 s73, 0
L_poll_qa:
    s_buffer_load_dwordx4 s[32:35], s[44:47], s18 glc
    s_add_u32 s73, s73, 1
    s_cmp_gt_u32 s73, 200000
    s_waitcnt lgkmcnt(0)
    s_cbranch_scc1 L_polled_qa
    s_xor_b32 s32, s32, s59
    s_xor_b32 s33, s33, s59
    s_xor_b32 s34, s34, s59
    s_xor_b32 s35, s35, s59
    s_or_b64 s[32:33], s[32:33], s[34:35]
    s_cmp_eq_u64 s[32:33], 0
    s_cbranch_scc0 L_poll_qa
L_polled_qa:
    buffer_load_dwordx4 v[112:115], v248, s[44:47], s8 offen offset:0 sc1
    buffer_load_dwordx4 v[116:119], v248, s[44:47], s8 offen offset:1024 sc1
    buffer_load_dwordx4 v[120:123], v248, s[44:47], s8 offen offset:2048 sc1
    buffer_load_dwordx4 v[124:127], v248, s[44:47], s8 offen offset:3072 sc1
    buffer_load_dwordx4 v[128:131], v248, s[44:47], s14 offen offset:0 sc1
    buffer_load_dwordx4 v[132:135], v248, s[44:47], s14 offen offset:1024 sc1
    buffer_load_dwordx4 v[136:139], v248, s[44:47], s14 offen offset:2048 sc1
    buffer_load_dwordx4 v[140:143], v248, s[44:47], s14 offen offset:3072 sc1
    s_waitcnt vmcnt(19)
    ds_read_b64_tr_b16 a[208:209], v111 offset:7168
    ds_read_b64_tr_b16 a[212:213], v111 offset:7176
    s_waitcnt vmcnt(18)
    ds_read_b64_tr_b16 a[210:211], v111 offset:8192
    ds_read_b64_tr_b16 a[214:215], v111 offset:8200
    s_waitcnt vmcnt(17)
    ds_read_b64_tr_b16 a[216:217], v111 offset:9216
    ds_read_b64_tr_b16 a[220:221], v111 offset:9224
    s_waitcnt vmcnt(16)
    ds_read_b64_tr_b16 a[218:219], v111 offset:10240
    ds_read_b64_tr_b16 a[222:223], v111 offset:10248
    s_waitcnt vmcnt(15)
    ds_read_b64_tr_b16 a[224:225], v111 offset:11264
    ds_read_b64_tr_b16 a[228:229], v111 offset:11272
    s_waitcnt vmcnt(14)
    ds_read_b64_tr_b16 a[226:227], v111 offset:12288
    ds_read_b64_tr_b16 a[230:231], v111 offset:12296
    s_waitcnt vmcnt(13)
    ds_read_b64_tr_b16 a[232:233], v111 offset:13312
    ds_read_b64_tr_b16 a[236:237], v111 offset:13320
    s_waitcnt vmcnt(12)
    ds_read_b64_tr_b16 a[234:235], v111 offset:14336
    ds_read_b64_tr_b16 a[238:239], v111 offset:14344
    s_waitcnt vmcnt(11)
    ds_read_b64_tr_b16 a[240:241], v111 offset:0
    ds_read_b64_tr_b16 a[244:245], v111 offset:8
    s_waitcnt vmcnt(10)
    ds_read_b64_tr_b16 a[242:243], v111 offset:1024
    ds_read_b64_tr_b16 a[246:247], v111 offset:1032
    s_waitcnt vmcnt(9)
    ds_read_b64_tr_b16 a[248:249], v111 offset:2048
    ds_read_b64_tr_b16 a[252:253], v111 offset:2056
    s_waitcnt vmcnt(8)
    ds_read_b64_tr_b16 a[250:251], v111 offset:3072
    ds_read_b64_tr_b16 a[254:255], v111 offset:3080
    s_waitcnt lgkmcnt(0)
    s_barrier
    ds_read_b128 v[144:147], v234 offset:0
    ds_read_b128 v[148:151], v234 offset:512
    ds_read_b128 v[152:155], v234 offset:64
    ds_read_b128 v[156:159], v234 offset:576
    ds_read_b128 v[160:163], v234 offset:128
    ds_read_b128 v[164:167], v234 offset:640
    ds_read_b128 v[168:171], v234 offset:192
    ds_read_b128 v[172:175], v234 offset:704
    ds_write_b128 v235, v[64:67] offset:2080
    ds_write_b128 v235, v[68:71] offset:3136
    ds_write_b128 v235, v[72:75] offset:0
    ds_write_b128 v235, v[76:79] offset:1056
    ds_write_b128 v235, v[80:83] offset:18720
    ds_write_b128 v235, v[84:87] offset:19776
    ds_write_b128 v235, v[88:91] offset:16640
    ds_write_b128 v235, v[92:95] offset:17696
    ds_write_b128 v235, v[96:99] offset:35360
    ds_write_b128 v235, v[100:103] offset:36416
    ds_write_b128 v235, v[224:227] offset:33280
    ds_write_b128 v235, v[228:231] offset:34336
    s_waitcnt vmcnt(0)
L_q_landed:
    s_mov_b32 s72, 16640
    s_mov_b32 s15, 0
    s_cmp_ge_u32 s67, 4
    s_cselect_b32 s15, 2, s15
    s_cmp_ge_u32 s67, 5
    s_cselect_b32 s15, 18, s15
    s_cmp_ge_u32 s67, 6
    s_cselect_b32 s15, 82, s15
    s_cmp_ge_u32 s67, 7
    s_cselect_b32 s15, 594, s15
    s_cmp_ge_u32 s67, 8
    s_cselect_b32 s15, 2642, s15
    s_mov_b32 s62, 0
    s_cmp_eq_u32 s58, 0
    s_cselect_b32 s15, s62, s15
    s_lshr_b32 s62, s2, 4
    s_and_b32 s62, s62, 7
    s_cmp_eq_u32 s58, 0
    s_cselect_b32 s63, 8, 3
    s_mul_i32 s62, s62, s63
    s_lshr_b32 s62, s62, 3
    s_lshl_b32 s15, s15, s62
    s_lshr_b32 s69, s68, 1
    s_sub_u32 s69, s69, 1
    s_mov_b32 s16, 0
    s_cmp_eq_u32 s58, 0
    s_cselect_b32 s78, 30, 14
    s_lshr_b32 s62, s2, 6
    s_and_b32 s62, s62, 1
    s_add_u32 s78, s78, s62
    s_sub_u32 s62, s69, 1
    s_min_u32 s78, s78, s62
    s_waitcnt lgkmcnt(0)
    v_mfma_f32_16x16x32_bf16 v[64:67], v[144:147], v[112:115], 0
    v_mfma_f32_16x16x32_bf16 v[72:75], v[144:147], v[128:131], 0
    v_mfma_f32_16x16x32_bf16 v[76:79], v[148:151], v[128:131], 0
    v_mfma_f32_16x16x32_bf16 v[68:71], v[148:151], v[112:115], 0
    v_mfma_f32_16x16x32_bf16 v[64:67], v[152:155], v[116:119], v[64:67]
    v_mfma_f32_16x16x32_bf16 v[72:75], v[152:155], v[132:135], v[72:75]
    v_mfma_f32_16x16x32_bf16 v[76:79], v[156:159], v[132:135], v[76:79]
    v_mfma_f32_16x16x32_bf16 v[68:71], v[156:159], v[116:119], v[68:71]
    v_mfma_f32_16x16x32_bf16 v[64:67], v[160:163], v[120:123], v[64:67]
    v_mfma_f32_16x16x32_bf16 v[72:75], v[160:163], v[136:139], v[72:75]
    v_mfma_f32_16x16x32_bf16 v[76:79], v[164:167], v[136:139], v[76:79]
    v_mfma_f32_16x16x32_bf16 v[68:71], v[164:167], v[120:123], v[68:71]
    v_mfma_f32_16x16x32_bf16 v[64:67], v[168:171], v[124:127], v[64:67]
    v_mfma_f32_16x16x32_bf16 v[72:75], v[168:171], v[140:143], v[72:75]
    v_mfma_f32_16x16x32_bf16 v[76:79], v[172:175], v[140:143], v[76:79]
    v_mfma_f32_16x16x32_bf16 v[68:71], v[172:175], v[124:127], v[68:71]
    v_add_u32 v234, s72, v232
    v_add_u32 v235, s72, v233
    s_nop 5
    v_max3_f32 v250, v64, v65, v66
    v_max3_f32 v251, v67, v68, v69
    v_max3_f32 v250, v250, v70, v71
    v_max_f32 v250, v250, v251
    v_mov_b32 v251, v250
    s_nop 1
    v_permlane16_swap_b32 v251, v250
    v_max_f32 v250, v250, v251
    v_mov_b32 v251, v250
    s_nop 1
    v_permlane32_swap_b32 v251, v250
    v_max_f32 v250, v250, v251
    v_add_f32 v250, 0x41600000, v250
    v_sub_f32 v64, v64, v250
    v_sub_f32 v65, v65, v250
    v_sub_f32 v66, v66, v250
    v_sub_f32 v67, v67, v250
    v_sub_f32 v68, v68, v250
    v_sub_f32 v69, v69, v250
    v_sub_f32 v70, v70, v250
    v_sub_f32 v71, v71, v250
    v_sub_f32 v96, 0, v250
    v_sub_f32 v97, 0, v250
    v_sub_f32 v98, 0, v250
    v_sub_f32 v99, 0, v250
    v_max3_f32 v250, v72, v73, v74
    v_max3_f32 v251, v75, v76, v77
    v_max3_f32 v250, v250, v78, v79
    v_max_f32 v250, v250, v251
    v_mov_b32 v251, v250
    s_nop 1
    v_permlane16_swap_b32 v251, v250
    v_max_f32 v250, v250, v251
    v_mov_b32 v251, v250
    s_nop 1
    v_permlane32_swap_b32 v251, v250
    v_max_f32 v250, v250, v251
    v_add_f32 v250, 0x41600000, v250
    v_sub_f32 v72, v72, v250
    v_sub_f32 v73, v73, v250
    v_sub_f32 v74, v74, v250
    v_sub_f32 v75, v75, v250
    v_sub_f32 v76, v76, v250
    v_sub_f32 v77, v77, v250
    v_sub_f32 v78, v78, v250
    v_sub_f32 v79, v79, v250
    v_sub_f32 v100, 0, v250
    v_sub_f32 v101, 0, v250
    v_sub_f32 v102, 0, v250
    v_sub_f32 v103, 0, v250
    s_waitcnt vmcnt(8) lgkmcnt(0)
    s_barrier
    s_sub_u32 s66, s66, 8192
L_early:
    v_mfma_f32_16x16x32_bf16 v[0:3], v[176:179], v[216:219], v[0:3]
    s_add_u32 s66, s66, 8192
    s_mov_b32 m0, s71
    ds_read_b128 v[144:147], v234 offset:0
    ds_read_b128 v[148:151], v234 offset:512
    v_mfma_f32_16x16x32_bf16 v[32:35], v[176:179], v[220:223], v[32:35]
    s_add_u32 s71, s71, 16640
    buffer_load_dwordx4 v236, s[24:27], s66 offen offset:2080 nt lds
    v_mfma_f32_16x16x32_bf16 v[36:39], v[180:183], v[220:223], v[36:39]
    s_cmp_eq_u32 s71, s76
    ds_read_b128 v[152:155], v234 offset:64
    v_exp_f32 v224, v64
    v_mfma_f32_16x16x32_bf16 v[4:7], v[180:183], v[216:219], v[4:7]
    s_cselect_b32 s71, s70, s71
    ds_read_b128 v[156:159], v234 offset:576
    ds_read_b128 v[160:163], v234 offset:128
    v_mfma_f32_16x16x32_bf16 v[8:11], v[184:187], v[216:219], v[8:11]
    v_exp_f32 v225, v65
    v_mfma_f32_16x16x32_bf16 v[40:43], v[184:187], v[220:223], v[40:43]
    s_add_u32 s72, s72, 16640
    ds_read_b128 v[164:167], v234 offset:640
    ds_read_b128 v[168:171], v234 offset:192
    v_mfma_f32_16x16x32_bf16 v[44:47], v[188:191], v[220:223], v[44:47]
    s_cmp_eq_u32 s72, 149760
    v_exp_f32 v226, v66
    v_cvt_pk_bf16_f32 v208, v224, v225
    v_mfma_f32_16x16x32_bf16 v[12:15], v[188:191], v[216:219], v[12:15]
    s_cselect_b32 s72, 0, s72
    ds_read_b64_tr_b16 v[176:177], v235 offset:0
    ds_read_b128 v[172:175], v234 offset:704
    ds_read_b64_tr_b16 v[178:179], v235 offset:512
    v_mfma_f32_16x16x32_bf16 v[16:19], v[192:195], v[216:219], v[16:19]
    v_exp_f32 v227, v67
    v_mfma_f32_16x16x32_bf16 v[48:51], v[192:195], v[220:223], v[48:51]
    ds_read_b64_tr_b16 v[180:181], v235 offset:32
    buffer_load_dwordx4 v237, s[24:27], s66 offen offset:3136 nt lds
    v_mfma_f32_16x16x32_bf16 v[52:55], v[196:199], v[220:223], v[52:55]
    v_exp_f32 v228, v68
    v_mfma_f32_16x16x32_bf16 v[20:23], v[196:199], v[216:219], v[20:23]
    ds_read_b64_tr_b16 v[182:183], v235 offset:544
    v_cvt_pk_bf16_f32 v209, v226, v227
    v_mfma_f32_16x16x32_bf16 v[24:27], v[200:203], v[216:219], v[24:27]
    ds_read_b64_tr_b16 v[184:185], v235 offset:64
    v_exp_f32 v229, v69
    v_mfma_f32_16x16x32_bf16 v[56:59], v[200:203], v[220:223], v[56:59]
    ds_read_b64_tr_b16 v[186:187], v235 offset:576
    v_exp_f32 v230, v70
    v_mfma_f32_16x16x32_bf16 v[60:63], v[204:207], v[220:223], v[60:63]
    ds_read_b64_tr_b16 v[188:189], v235 offset:96
    v_cvt_pk_bf16_f32 v210, v228, v229
    v_mfma_f32_16x16x32_bf16 v[28:31], v[204:207], v[216:219], v[28:31]
    ds_read_b64_tr_b16 v[190:191], v235 offset:608
    v_exp_f32 v231, v71
    v_mfma_f32_16x16x32_bf16 v[240:243], v[104:107], v[216:219], v[240:243]
    buffer_load_dwordx4 v238, s[28:31], s66 offen nt lds
    v_or3_b32 v249, v208, v209, v210
    v_mfma_f32_16x16x32_bf16 v[244:247], v[104:107], v[220:223], v[244:247]
    s_waitcnt lgkmcnt(7)
    ds_read_b64_tr_b16 v[192:193], v235 offset:128
    v_exp_f32 v224, v72
    v_mfma_f32_16x16x32_bf16 v[80:83], v[144:147], v[112:115], v[96:99]
    s_bitcmp1_b32 s15, s16
    ds_read_b64_tr_b16 v[194:195], v235 offset:640
    v_cvt_pk_bf16_f32 v211, v230, v231
    v_mfma_f32_16x16x32_bf16 v[88:91], v[144:147], v[128:131], v[100:103]
    v_exp_f32 v225, v73
    v_mfma_f32_16x16x32_bf16 v[92:95], v[148:151], v[128:131], v[100:103]
    ds_read_b64_tr_b16 v[196:197], v235 offset:160
    ds_read_b64_tr_b16 v[198:199], v235 offset:672
    v_mfma_f32_16x16x32_bf16 v[84:87], v[148:151], v[112:115], v[96:99]
    v_exp_f32 v226, v74
    v_mfma_f32_16x16x32_bf16 v[80:83], v[152:155], v[116:119], v[80:83]
    ds_read_b64_tr_b16 v[200:201], v235 offset:192
    v_cvt_pk_bf16_f32 v212, v224, v225
    v_mfma_f32_16x16x32_bf16 v[88:91], v[152:155], v[132:135], v[88:91]
    v_exp_f32 v227, v75
    v_mfma_f32_16x16x32_bf16 v[92:95], v[156:159], v[132:135], v[92:95]
    ds_read_b64_tr_b16 v[202:203], v235 offset:704
    v_or3_b32 v249, v249, v211, v212
    v_mfma_f32_16x16x32_bf16 v[84:87], v[156:159], v[116:119], v[84:87]
    ds_read_b64_tr_b16 v[204:205], v235 offset:224
    v_exp_f32 v228, v76
    v_mfma_f32_16x16x32_bf16 v[80:83], v[160:163], v[120:123], v[80:83]
    ds_read_b64_tr_b16 v[206:207], v235 offset:736
    v_cvt_pk_bf16_f32 v213, v226, v227
    v_mfma_f32_16x16x32_bf16 v[88:91], v[160:163], v[136:139], v[88:91]
    v_exp_f32 v229, v77
    v_mfma_f32_16x16x32_bf16 v[92:95], v[164:167], v[136:139], v[92:95]
    v_exp_f32 v230, v78
    v_cvt_pk_bf16_f32 v214, v228, v229
    v_mfma_f32_16x16x32_bf16 v[84:87], v[164:167], v[120:123], v[84:87]
    v_exp_f32 v231, v79
    v_or3_b32 v249, v249, v213, v214
    v_mfma_f32_16x16x32_bf16 v[80:83], v[168:171], v[124:127], v[80:83]
    v_add_u32 v234, s72, v232
    v_cvt_pk_bf16_f32 v215, v230, v231
    v_mfma_f32_16x16x32_bf16 v[88:91], v[168:171], v[140:143], v[88:91]
    v_bitop3_b32 v249, v249, v215, s74 bitop3:0xa8
    v_cmp_ne_u32 vcc, 0, v249
    v_add_u32 v235, s72, v233
    v_mfma_f32_16x16x32_bf16 v[92:95], v[172:175], v[140:143], v[92:95]
    buffer_load_dwordx4 v239, s[28:31], s66 offen offset:1056 nt lds
    v_mfma_f32_16x16x32_bf16 v[84:87], v[172:175], v[124:127], v[84:87]
    s_cbranch_vccnz L_rare_ea
L_back_ea:
    s_waitcnt vmcnt(5) lgkmcnt(0)
    s_barrier
    s_cbranch_scc1 L_skip
    v_mfma_f32_16x16x32_bf16 v[0:3], v[176:179], v[208:211], v[0:3]
    s_add_u32 s66, s66, 8192
    s_mov_b32 m0, s71
    ds_read_b128 v[144:147], v234 offset:0
    ds_read_b128 v[148:151], v234 offset:512
    v_mfma_f32_16x16x32_bf16 v[32:35], v[176:179], v[212:215], v[32:35]
    s_add_u32 s71, s71, 16640
    buffer_load_dwordx4 v236, s[24:27], s66 offen offset:2080 nt lds
    v_mfma_f32_16x16x32_bf16 v[36:39], v[180:183], v[212:215], v[36:39]
    s_cmp_eq_u32 s71, s76
    ds_read_b128 v[152:155], v234 offset:64
    v_exp_f32 v224, v80
    v_mfma_f32_16x16x32_bf16 v[4:7], v[180:183], v[208:211], v[4:7]
    s_cselect_b32 s71, s70, s71
    ds_read_b128 v[156:159], v234 offset:576
    ds_read_b128 v[160:163], v234 offset:128
    v_mfma_f32_16x16x32_bf16 v[8:11], v[184:187], v[208:211], v[8:11]
    v_exp_f32 v225, v81
    v_mfma_f32_16x16x32_bf16 v[40:43], v[184:187], v[212:215], v[40:43]
    s_add_u32 s72, s72, 16640
    ds_read_b128 v[164:167], v234 offset:640
    ds_read_b128 v[168:171], v234 offset:192
    v_mfma_f32_16x16x32_bf16 v[44:47], v[188:191], v[212:215], v[44:47]
    s_cmp_eq_u32 s72, 149760
    v_exp_f32 v226, v82
    v_cvt_pk_bf16_f32 v216, v224, v225
    v_mfma_f32_16x16x32_bf16 v[12:15], v[188:191], v[208:211], v[12:15]
    s_cselect_b32 s72, 0, s72
    ds_read_b64_tr_b16 v[176:177], v235 offset:0
    ds_read_b128 v[172:175], v234 offset:704
    ds_read_b64_tr_b16 v[178:179], v235 offset:512
    v_mfma_f32_16x16x32_bf16 v[16:19], v[192:195], v[208:211], v[16:19]
    v_exp_f32 v227, v83
    v_mfma_f32_16x16x32_bf16 v[48:51], v[192:195], v[212:215], v[48:51]
    ds_read_b64_tr_b16 v[180:181], v235 offset:32
    buffer_load_dwordx4 v237, s[24:27], s66 offen offset:3136 nt lds
    v_mfma_f32_16x16x32_bf16 v[52:55], v[196:199], v[212:215], v[52:55]
    v_exp_f32 v228, v84
    v_mfma_f32_16x16x32_bf16 v[20:23], v[196:199], v[208:211], v[20:23]
    ds_read_b64_tr_b16 v[182:183], v235 offset:544
    v_cvt_pk_bf16_f32 v217, v226, v227
    v_mfma_f32_16x16x32_bf16 v[24:27], v[200:203], v[208:211], v[24:27]
    ds_read_b64_tr_b16 v[184:185], v235 offset:64
    v_exp_f32 v229, v85
    v_mfma_f32_16x16x32_bf16 v[56:59], v[200:203], v[212:215], v[56:59]
    ds_read_b64_tr_b16 v[186:187], v235 offset:576
    v_exp_f32 v230, v86
    v_mfma_f32_16x16x32_bf16 v[60:63], v[204:207], v[212:215], v[60:63]
    ds_read_b64_tr_b16 v[188:189], v235 offset:96
    v_cvt_pk_bf16_f32 v218, v228, v229
    v_mfma_f32_16x16x32_bf16 v[28:31], v[204:207], v[208:211], v[28:31]
    ds_read_b64_tr_b16 v[190:191], v235 offset:608
    v_exp_f32 v231, v87
    v_mfma_f32_16x16x32_bf16 v[240:243], v[104:107], v[208:211], v[240:243]
    buffer_load_dwordx4 v238, s[28:31], s66 offen nt lds
    v_or3_b32 v249, v216, v217, v218
    v_mfma_f32_16x16x32_bf16 v[244:247], v[104:107], v[212:215], v[244:247]
    s_waitcnt lgkmcnt(7)
    ds_read_b64_tr_b16 v[192:193], v235 offset:128
    v_exp_f32 v224, v88
    v_mfma_f32_16x16x32_bf16 v[64:67], v[144:147], v[112:115], v[96:99]
    s_add_u32 s16, s16, 1
    ds_read_b64_tr_b16 v[194:195], v235 offset:640
    v_cvt_pk_bf16_f32 v219, v230, v231
    v_mfma_f32_16x16x32_bf16 v[72:75], v[144:147], v[128:131], v[100:103]
    v_exp_f32 v225, v89
    v_mfma_f32_16x16x32_bf16 v[76:79], v[148:151], v[128:131], v[100:103]
    ds_read_b64_tr_b16 v[196:197], v235 offset:160
    ds_read_b64_tr_b16 v[198:199], v235 offset:672
    v_mfma_f32_16x16x32_bf16 v[68:71], v[148:151], v[112:115], v[96:99]
    v_exp_f32 v226, v90
    v_mfma_f32_16x16x32_bf16 v[64:67], v[152:155], v[116:119], v[64:67]
    ds_read_b64_tr_b16 v[200:201], v235 offset:192
    v_cvt_pk_bf16_f32 v220, v224, v225
    v_mfma_f32_16x16x32_bf16 v[72:75], v[152:155], v[132:135], v[72:75]
    v_exp_f32 v227, v91
    v_mfma_f32_16x16x32_bf16 v[76:79], v[156:159], v[132:135], v[76:79]
    ds_read_b64_tr_b16 v[202:203], v235 offset:704
    v_or3_b32 v249, v249, v219, v220
    v_mfma_f32_16x16x32_bf16 v[68:71], v[156:159], v[116:119], v[68:71]
    ds_read_b64_tr_b16 v[204:205], v235 offset:224
    v_exp_f32 v228, v92
    v_mfma_f32_16x16x32_bf16 v[64:67], v[160:163], v[120:123], v[64:67]
    ds_read_b64_tr_b16 v[206:207], v235 offset:736
    v_cvt_pk_bf16_f32 v221, v226, v227
    v_mfma_f32_16x16x32_bf16 v[72:75], v[160:163], v[136:139], v[72:75]
    v_exp_f32 v229, v93
    v_mfma_f32_16x16x32_bf16 v[76:79], v[164:167], v[136:139], v[76:79]
    v_exp_f32 v230, v94
    v_cvt_pk_bf16_f32 v222, v228, v229
    v_mfma_f32_16x16x32_bf16 v[68:71], v[164:167], v[120:123], v[68:71]
    v_exp_f32 v231, v95
    v_or3_b32 v249, v249, v221, v222
    v_mfma_f32_16x16x32_bf16 v[64:67], v[168:171], v[124:127], v[64:67]
    v_add_u32 v234, s72, v232
    v_cvt_pk_bf16_f32 v223, v230, v231
    v_mfma_f32_16x16x32_bf16 v[72:75], v[168:171], v[140:143], v[72:75]
    v_bitop3_b32 v249, v249, v223, s74 bitop3:0xa8
    v_cmp_ne_u32 vcc, 0, v249
    v_add_u32 v235, s72, v233
    v_mfma_f32_16x16x32_bf16 v[76:79], v[172:175], v[140:143], v[76:79]
    buffer_load_dwordx4 v239, s[28:31], s66 offen offset:1056 nt lds
    v_mfma_f32_16x16x32_bf16 v[68:71], v[172:175], v[124:127], v[68:71]
    s_cbranch_vccnz L_rare_eb
L_back_eb:
    s_waitcnt vmcnt(5) lgkmcnt(0)
    s_barrier
L_dispatch:
    s_cmp_lt_u32 s16, s78
    s_cbranch_scc1 L_early
L_c0:
    v_mfma_f32_16x16x32_bf16 v[0:3], v[176:179], v[216:219], v[0:3]
    s_add_u32 s66, s66, 8192
    s_mov_b32 m0, s71
    ds_read_b128 v[144:147], v234 offset:0
    ds_read_b128 v[148:151], v234 offset:512
    v_mfma_f32_16x16x32_bf16 v[32:35], v[176:179], v[220:223], v[32:35]
    s_add_u32 s71, s71, 16640
    buffer_load_dwordx4 v236, s[24:27], s66 offen offset:2080 nt lds
    v_mfma_f32_16x16x32_bf16 v[36:39], v[180:183], v[220:223], v[36:39]
    s_cmp_eq_u32 s71, s76
    ds_read_b128 v[152:155], v234 offset:64
    v_exp_f32 v224, v64
    v_mfma_f32_16x16x32_bf16 v[4:7], v[180:183], v[216:219], v[4:7]
    s_cselect_b32 s71, s70, s71
    ds_read_b128 v[156:159], v234 offset:576
    ds_read_b128 v[160:163], v234 offset:128
    v_mfma_f32_16x16x32_bf16 v[8:11], v[184:187], v[216:219], v[8:11]
    v_exp_f32 v225, v65
    v_mfma_f32_16x16x32_bf16 v[40:43], v[184:187], v[220:223], v[40:43]
    s_add_u32 s72, s72, 16640
    ds_read_b128 v[164:167], v234 offset:640
    ds_read_b128 v[168:171], v234 offset:192
    v_mfma_f32_16x16x32_bf16 v[44:47], v[188:191], v[220:223], v[44:47]
    s_cmp_eq_u32 s72, 149760
    v_exp_f32 v226, v66
    v_cvt_pk_bf16_f32 v208, v224, v225
    v_mfma_f32_16x16x32_bf16 v[12:15], v[188:191], v[216:219], v[12:15]
    s_cselect_b32 s72, 0, s72
    ds_read_b64_tr_b16 v[176:177], v235 offset:0
    ds_read_b128 v[172:175], v234 offset:704
    ds_read_b64_tr_b16 v[178:179], v235 offset:512
    v_mfma_f32_16x16x32_bf16 v[16:19], v[192:195], v[216:219], v[16:19]
    v_exp_f32 v227, v67
    v_mfma_f32_16x16x32_bf16 v[48:51], v[192:195], v[220:223], v[48:51]
    ds_read_b64_tr_b16 v[180:181], v235 offset:32
    buffer_load_dwordx4 v237, s[24:27], s66 offen offset:3136 nt lds
    v_mfma_f32_16x16x32_bf16 v[52:55], v[196:199], v[220:223], v[52:55]
    v_exp_f32 v228, v68
    v_mfma_f32_16x16x32_bf16 v[20:23], v[196:199], v[216:219], v[20:23]
    ds_read_b64_tr_b16 v[182:183], v235 offset:544
    v_cvt_pk_bf16_f32 v209, v226, v227
    v_mfma_f32_16x16x32_bf16 v[24:27], v[200:203], v[216:219], v[24:27]
    ds_read_b64_tr_b16 v[184:185], v235 offset:64
    v_exp_f32 v229, v69
    v_mfma_f32_16x16x32_bf16 v[56:59], v[200:203], v[220:223], v[56:59]
    ds_read_b64_tr_b16 v[186:187], v235 offset:576
    v_exp_f32 v230, v70
    v_mfma_f32_16x16x32_bf16 v[60:63], v[204:207], v[220:223], v[60:63]
    ds_read_b64_tr_b16 v[188:189], v235 offset:96
    v_cvt_pk_bf16_f32 v210, v228, v229
    v_mfma_f32_16x16x32_bf16 v[28:31], v[204:207], v[216:219], v[28:31]
    ds_read_b64_tr_b16 v[190:191], v235 offset:608
    v_exp_f32 v231, v71
    v_mfma_f32_16x16x32_bf16 v[240:243], v[104:107], v[216:219], v[240:243]
    buffer_load_dwordx4 v238, s[28:31], s66 offen nt lds
    v_or3_b32 v249, v208, v209, v210
    v_mfma_f32_16x16x32_bf16 v[244:247], v[104:107], v[220:223], v[244:247]
    s_waitcnt lgkmcnt(7)
    ds_read_b64_tr_b16 v[192:193], v235 offset:128
    v_exp_f32 v224, v72
    v_mfma_f32_16x16x32_bf16 v[80:83], v[144:147], v[112:115], v[96:99]
    s_bitcmp1_b32 s15, s16
    ds_read_b64_tr_b16 v[194:195], v235 offset:640
    v_cvt_pk_bf16_f32 v211, v230, v231
    v_mfma_f32_16x16x32_bf16 v[88:91], v[144:147], v[128:131], v[100:103]
    v_exp_f32 v225, v73
    v_mfma_f32_16x16x32_bf16 v[92:95], v[148:151], v[128:131], v[100:103]
    ds_read_b64_tr_b16 v[196:197], v235 offset:160
    ds_read_b64_tr_b16 v[198:199], v235 offset:672
    v_mfma_f32_16x16x32_bf16 v[84:87], v[148:151], v[112:115], v[96:99]
    v_exp_f32 v226, v74
    v_mfma_f32_16x16x32_bf16 v[80:83], v[152:155], v[116:119], v[80:83]
    ds_read_b64_tr_b16 v[200:201], v235 offset:192
    v_cvt_pk_bf16_f32 v212, v224, v225
    v_mfma_f32_16x16x32_bf16 v[88:91], v[152:155], v[132:135], v[88:91]
    v_exp_f32 v227, v75
    v_mfma_f32_16x16x32_bf16 v[92:95], v[156:159], v[132:135], v[92:95]
    ds_read_b64_tr_b16 v[202:203], v235 offset:704
    v_or3_b32 v249, v249, v211, v212
    v_mfma_f32_16x16x32_bf16 v[84:87], v[156:159], v[116:119], v[84:87]
    ds_read_b64_tr_b16 v[204:205], v235 offset:224
    v_exp_f32 v228, v76
    v_mfma_f32_16x16x32_bf16 v[80:83], v[160:163], v[120:123], v[80:83]
    ds_read_b64_tr_b16 v[206:207], v235 offset:736
    v_cvt_pk_bf16_f32 v213, v226, v227
    v_mfma_f32_16x16x32_bf16 v[88:91], v[160:163], v[136:139], v[88:91]
    v_exp_f32 v229, v77
    v_mfma_f32_16x16x32_bf16 v[92:95], v[164:167], v[136:139], v[92:95]
    v_exp_f32 v230, v78
    v_cvt_pk_bf16_f32 v214, v228, v229
    v_mfma_f32_16x16x32_bf16 v[84:87], v[164:167], v[120:123], v[84:87]
    v_exp_f32 v231, v79
    v_or3_b32 v249, v249, v213, v214
    v_mfma_f32_16x16x32_bf16 v[80:83], v[168:171], v[124:127], v[80:83]
    v_add_u32 v234, s72, v232
    v_cvt_pk_bf16_f32 v215, v230, v231
    v_mfma_f32_16x16x32_bf16 v[88:91], v[168:171], v[140:143], v[88:91]
    v_bitop3_b32 v249, v249, v215, s74 bitop3:0xa8
    v_cmp_ne_u32 vcc, 0, v249
    v_add_u32 v235, s72, v233
    v_mfma_f32_16x16x32_bf16 v[92:95], v[172:175], v[140:143], v[92:95]
    buffer_load_dwordx4 v239, s[28:31], s66 offen offset:1056 nt lds
    v_mfma_f32_16x16x32_bf16 v[84:87], v[172:175], v[124:127], v[84:87]
    s_cbranch_vccnz L_rare_ca0
L_back_ca0:
    s_waitcnt vmcnt(8) lgkmcnt(0)
    s_barrier
    s_cbranch_scc1 L_skip
L_cb0:
    v_mfma_f32_16x16x32_bf16 v[0:3], v[176:179], v[208:211], v[0:3]
    s_add_u32 s66, s66, 8192
    s_mov_b32 m0, s71
    ds_read_b128 v[144:147], v234 offset:0
    ds_read_b128 v[148:151], v234 offset:512
    v_mfma_f32_16x16x32_bf16 v[32:35], v[176:179], v[212:215], v[32:35]
    s_add_u32 s71, s71, 16640
    buffer_load_dwordx4 v236, s[24:27], s66 offen offset:2080 nt lds
    v_mfma_f32_16x16x32_bf16 v[36:39], v[180:183], v[212:215], v[36:39]
    s_cmp_eq_u32 s71, s76
    ds_read_b128 v[152:155], v234 offset:64
    v_exp_f32 v224, v80
    v_mfma_f32_16x16x32_bf16 v[4:7], v[180:183], v[208:211], v[4:7]
    s_cselect_b32 s71, s70, s71
    ds_read_b128 v[156:159], v234 offset:576
    ds_read_b128 v[160:163], v234 offset:128
    v_mfma_f32_16x16x32_bf16 v[8:11], v[184:187], v[208:211], v[8:11]
    v_exp_f32 v225, v81
    v_mfma_f32_16x16x32_bf16 v[40:43], v[184:187], v[212:215], v[40:43]
    s_add_u32 s72, s72, 16640
    ds_read_b128 v[164:167], v234 offset:640
    ds_read_b128 v[168:171], v234 offset:192
    v_mfma_f32_16x16x32_bf16 v[44:47], v[188:191], v[212:215], v[44:47]
    s_cmp_eq_u32 s72, 149760
    v_exp_f32 v226, v82
    v_cvt_pk_bf16_f32 v216, v224, v225
    v_mfma_f32_16x16x32_bf16 v[12:15], v[188:191], v[208:211], v[12:15]
    s_cselect_b32 s72, 0, s72
    ds_read_b64_tr_b16 v[176:177], v235 offset:0
    ds_read_b128 v[172:175], v234 offset:704
    ds_read_b64_tr_b16 v[178:179], v235 offset:512
    v_mfma_f32_16x16x32_bf16 v[16:19], v[192:195], v[208:211], v[16:19]
    v_exp_f32 v227, v83
    v_mfma_f32_16x16x32_bf16 v[48:51], v[192:195], v[212:215], v[48:51]
    ds_read_b64_tr_b16 v[180:181], v235 offset:32
    buffer_load_dwordx4 v237, s[24:27], s66 offen offset:3136 nt lds
    v_mfma_f32_16x16x32_bf16 v[52:55], v[196:199], v[212:215], v[52:55]
    v_exp_f32 v228, v84
    v_mfma_f32_16x16x32_bf16 v[20:23], v[196:199], v[208:211], v[20:23]
    ds_read_b64_tr_b16 v[182:183], v235 offset:544
    v_cvt_pk_bf16_f32 v217, v226, v227
    v_mfma_f32_16x16x32_bf16 v[24:27], v[200:203], v[208:211], v[24:27]
    ds_read_b64_tr_b16 v[184:185], v235 offset:64
    v_exp_f32 v229, v85
    v_mfma_f32_16x16x32_bf16 v[56:59], v[200:203], v[212:215], v[56:59]
    ds_read_b64_tr_b16 v[186:187], v235 offset:576
    v_exp_f32 v230, v86
    v_mfma_f32_16x16x32_bf16 v[60:63], v[204:207], v[212:215], v[60:63]
    ds_read_b64_tr_b16 v[188:189], v235 offset:96
    v_cvt_pk_bf16_f32 v218, v228, v229
    v_mfma_f32_16x16x32_bf16 v[28:31], v[204:207], v[208:211], v[28:31]
    ds_read_b64_tr_b16 v[190:191], v235 offset:608
    v_exp_f32 v231, v87
    v_mfma_f32_16x16x32_bf16 v[240:243], v[104:107], v[208:211], v[240:243]
    buffer_load_dwordx4 v238, s[28:31], s66 offen nt lds
    v_or3_b32 v249, v216, v217, v218
    v_mfma_f32_16x16x32_bf16 v[244:247], v[104:107], v[212:215], v[244:247]
    s_waitcnt lgkmcnt(7)
    ds_read_b64_tr_b16 v[192:193], v235 offset:128
    v_exp_f32 v224, v88
    v_mfma_f32_16x16x32_bf16 v[64:67], v[144:147], v[112:115], v[96:99]
    s_add_u32 s16, s16, 1
    ds_read_b64_tr_b16 v[194:195], v235 offset:640
    v_cvt_pk_bf16_f32 v219, v230, v231
    v_mfma_f32_16x16x32_bf16 v[72:75], v[144:147], v[128:131], v[100:103]
    s_cmp_lt_u32 s16, s69
    v_exp_f32 v225, v89
    v_mfma_f32_16x16x32_bf16 v[76:79], v[148:151], v[128:131], v[100:103]
    ds_read_b64_tr_b16 v[196:197], v235 offset:160
    ds_read_b64_tr_b16 v[198:199], v235 offset:672
    v_mfma_f32_16x16x32_bf16 v[68:71], v[148:151], v[112:115], v[96:99]
    v_exp_f32 v226, v90
    v_mfma_f32_16x16x32_bf16 v[64:67], v[152:155], v[116:119], v[64:67]
    ds_read_b64_tr_b16 v[200:201], v235 offset:192
    v_cvt_pk_bf16_f32 v220, v224, v225
    v_mfma_f32_16x16x32_bf16 v[72:75], v[152:155], v[132:135], v[72:75]
    v_exp_f32 v227, v91
    v_mfma_f32_16x16x32_bf16 v[76:79], v[156:159], v[132:135], v[76:79]
    ds_read_b64_tr_b16 v[202:203], v235 offset:704
    v_or3_b32 v249, v249, v219, v220
    v_mfma_f32_16x16x32_bf16 v[68:71], v[156:159], v[116:119], v[68:71]
    ds_read_b64_tr_b16 v[204:205], v235 offset:224
    v_exp_f32 v228, v92
    v_mfma_f32_16x16x32_bf16 v[64:67], v[160:163], v[120:123], v[64:67]
    ds_read_b64_tr_b16 v[206:207], v235 offset:736
    v_cvt_pk_bf16_f32 v221, v226, v227
    v_mfma_f32_16x16x32_bf16 v[72:75], v[160:163], v[136:139], v[72:75]
    v_exp_f32 v229, v93
    v_mfma_f32_16x16x32_bf16 v[76:79], v[164:167], v[136:139], v[76:79]
    v_exp_f32 v230, v94
    v_cvt_pk_bf16_f32 v222, v228, v229
    v_mfma_f32_16x16x32_bf16 v[68:71], v[164:167], v[120:123], v[68:71]
    v_exp_f32 v231, v95
    v_or3_b32 v249, v249, v221, v222
    v_mfma_f32_16x16x32_bf16 v[64:67], v[168:171], v[124:127], v[64:67]
    v_add_u32 v234, s72, v232
    v_cvt_pk_bf16_f32 v223, v230, v231
    v_mfma_f32_16x16x32_bf16 v[72:75], v[168:171], v[140:143], v[72:75]
    v_bitop3_b32 v249, v249, v223, s74 bitop3:0xa8
    v_cmp_ne_u32 vcc, 0, v249
    v_add_u32 v235, s72, v233
    v_mfma_f32_16x16x32_bf16 v[76:79], v[172:175], v[140:143], v[76:79]
    buffer_load_dwordx4 v239, s[28:31], s66 offen offset:1056 nt lds
    v_mfma_f32_16x16x32_bf16 v[68:71], v[172:175], v[124:127], v[68:71]
    s_cbranch_vccnz L_rare_cb0
L_back_cb0:
    s_waitcnt vmcnt(8) lgkmcnt(0)
    s_barrier
    s_cbranch_scc1 L_c0
L_peel:
    v_mov_b32 v252, 0
    v_mfma_f32_16x16x32_bf16 v[0:3], v[176:179], v[216:219], v[0:3]
    ds_read_b128 v[144:147], v234 offset:0
    buffer_load_dword v252, v252, s[44:47], s13 offen sc1
    v_mfma_f32_16x16x32_bf16 v[32:35], v[176:179], v[220:223], v[32:35]
    ds_read_b128 v[148:151], v234 offset:512
    ds_read_b128 v[152:155], v234 offset:64
    v_mfma_f32_16x16x32_bf16 v[36:39], v[180:183], v[220:223], v[36:39]
    v_exp_f32 v224, v64
    v_mfma_f32_16x16x32_bf16 v[4:7], v[180:183], v[216:219], v[4:7]
    ds_read_b128 v[156:159], v234 offset:576
    ds_read_b128 v[160:163], v234 offset:128
    v_mfma_f32_16x16x32_bf16 v[8:11], v[184:187], v[216:219], v[8:11]
    v_exp_f32 v225, v65
    v_mfma_f32_16x16x32_bf16 v[40:43], v[184:187], v[220:223], v[40:43]
    s_add_u32 s72, s72, 16640
    ds_read_b128 v[164:167], v234 offset:640
    ds_read_b128 v[168:171], v234 offset:192
    v_mfma_f32_16x16x32_bf16 v[44:47], v[188:191], v[220:223], v[44:47]
    s_cmp_eq_u32 s72, 149760
    v_exp_f32 v226, v66
    v_mfma_f32_16x16x32_bf16 v[12:15], v[188:191], v[216:219], v[12:15]
    s_cselect_b32 s72, 0, s72
    ds_read_b64_tr_b16 v[176:177], v235 offset:0
    v_cvt_pk_bf16_f32 v208, v224, v225
    v_mfma_f32_16x16x32_bf16 v[16:19], v[192:195], v[216:219], v[16:19]
    ds_read_b128 v[172:175], v234 offset:704
    ds_read_b64_tr_b16 v[178:179], v235 offset:512
    v_mfma_f32_16x16x32_bf16 v[48:51], v[192:195], v[220:223], v[48:51]
    v_exp_f32 v227, v67
    v_mfma_f32_16x16x32_bf16 v[52:55], v[196:199], v[220:223], v[52:55]
    ds_read_b64_tr_b16 v[180:181], v235 offset:32
    v_exp_f32 v228, v68
    v_mfma_f32_16x16x32_bf16 v[20:23], v[196:199], v[216:219], v[20:23]
    ds_read_b64_tr_b16 v[182:183], v235 offset:544
    v_cvt_pk_bf16_f32 v209, v226, v227
    v_mfma_f32_16x16x32_bf16 v[24:27], v[200:203], v[216:219], v[24:27]
    ds_read_b64_tr_b16 v[184:185], v235 offset:64
    v_exp_f32 v229, v69
    v_mfma_f32_16x16x32_bf16 v[56:59], v[200:203], v[220:223], v[56:59]
    ds_read_b64_tr_b16 v[186:187], v235 offset:576
    v_exp_f32 v230, v70
    v_mfma_f32_16x16x32_bf16 v[60:63], v[204:207], v[220:223], v[60:63]
    ds_read_b64_tr_b16 v[188:189], v235 offset:96
    v_cvt_pk_bf16_f32 v210, v228, v229
    v_mfma_f32_16x16x32_bf16 v[28:31], v[204:207], v[216:219], v[28:31]
    ds_read_b64_tr_b16 v[190:191], v235 offset:608
    v_exp_f32 v231, v71
    v_mfma_f32_16x16x32_bf16 v[240:243], v[104:107], v[216:219], v[240:243]
    ds_read_b64_tr_b16 v[192:193], v235 offset:128
    v_or3_b32 v249, v208, v209, v210
    v_mfma_f32_16x16x32_bf16 v[244:247], v[104:107], v[220:223], v[244:247]
    s_waitcnt lgkmcnt(8)
    v_exp_f32 v224, v72
    v_mfma_f32_16x16x32_bf16 v[80:83], v[144:147], v[112:115], v[96:99]
    ds_read_b64_tr_b16 v[194:195], v235 offset:640
    v_cvt_pk_bf16_f32 v211, v230, v231
    v_mfma_f32_16x16x32_bf16 v[88:91], v[144:147], v[128:131], v[100:103]
    v_exp_f32 v225, v73
    v_mfma_f32_16x16x32_bf16 v[92:95], v[148:151], v[128:131], v[100:103]
    ds_read_b64_tr_b16 v[196:197], v235 offset:160
    ds_read_b64_tr_b16 v[198:199], v235 offset:672
    v_mfma_f32_16x16x32_bf16 v[84:87], v[148:151], v[112:115], v[96:99]
    v_exp_f32 v226, v74
    v_mfma_f32_16x16x32_bf16 v[80:83], v[152:155], v[116:119], v[80:83]
    ds_read_b64_tr_b16 v[200:201], v235 offset:192
    v_cvt_pk_bf16_f32 v212, v224, v225
    v_mfma_f32_16x16x32_bf16 v[88:91], v[152:155], v[132:135], v[88:91]
    v_exp_f32 v227, v75
    v_mfma_f32_16x16x32_bf16 v[92:95], v[156:159], v[132:135], v[92:95]
    ds_read_b64_tr_b16 v[202:203], v235 offset:704
    v_or3_b32 v249, v249, v211, v212
    v_mfma_f32_16x16x32_bf16 v[84:87], v[156:159], v[116:119], v[84:87]
    ds_read_b64_tr_b16 v[204:205], v235 offset:224
    v_exp_f32 v228, v76
    v_mfma_f32_16x16x32_bf16 v[80:83], v[160:163], v[120:123], v[80:83]
    ds_read_b64_tr_b16 v[206:207], v235 offset:736
    v_cvt_pk_bf16_f32 v213, v226, v227
    v_mfma_f32_16x16x32_bf16 v[88:91], v[160:163], v[136:139], v[88:91]
    v_exp_f32 v229, v77
    v_mfma_f32_16x16x32_bf16 v[92:95], v[164:167], v[136:139], v[92:95]
    v_exp_f32 v230, v78
    v_mfma_f32_16x16x32_bf16 v[84:87], v[164:167], v[120:123], v[84:87]
    v_cvt_pk_bf16_f32 v214, v228, v229
    v_exp_f32 v231, v79
    v_mfma_f32_16x16x32_bf16 v[80:83], v[168:171], v[124:127], v[80:83]
    v_or3_b32 v249, v249, v213, v214
    v_add_u32 v234, s72, v232
    v_mfma_f32_16x16x32_bf16 v[88:91], v[168:171], v[140:143], v[88:91]
    v_cvt_pk_bf16_f32 v215, v230, v231
    v_bitop3_b32 v249, v249, v215, s74 bitop3:0xa8
    v_mfma_f32_16x16x32_bf16 v[92:95], v[172:175], v[140:143], v[92:95]
    v_cmp_ne_u32 vcc, 0, v249
    v_add_u32 v235, s72, v233
    v_mfma_f32_16x16x32_bf16 v[84:87], v[172:175], v[124:127], v[84:87]
    s_cbranch_vccnz L_rare_a3
L_back_a3:
    s_waitcnt vmcnt(0) lgkmcnt(0)
    s_barrier
    v_readfirstlane_b32 s62, v252
    s_mov_b32 s77, 0
    s_cmp_eq_u32 s58, 0
    s_cbranch_scc1 L_pp_done
    s_cmp_eq_u32 s62, s59
    s_cbranch_scc0 L_pp_done
    s_mov_b32 s77, 1
    buffer_load_dwordx4 v[144:147], v248, s[44:47], s12 offen sc1
    buffer_load_dwordx4 v[112:115], v248, s[44:47], s10 offen offset:0 sc1
    buffer_load_dwordx4 v[116:119], v248, s[44:47], s10 offen offset:1024 sc1
    buffer_load_dwordx4 v[120:123], v248, s[44:47], s10 offen offset:2048 sc1
    buffer_load_dwordx4 v[124:127], v248, s[44:47], s10 offen offset:3072 sc1
    buffer_load_dwordx4 v[128:131], v248, s[44:47], s11 offen offset:0 sc1
    buffer_load_dwordx4 v[132:135], v248, s[44:47], s11 offen offset:1024 sc1
    buffer_load_dwordx4 v[136:139], v248, s[44:47], s11 offen offset:2048 sc1
    buffer_load_dwordx4 v[140:143], v248, s[44:47], s11 offen offset:3072 sc1
L_pp_done:
    v_mfma_f32_16x16x32_bf16 v[0:3], v[176:179], v[208:211], v[0:3]
    v_exp_f32 v224, v80
    v_mfma_f32_16x16x32_bf16 v[32:35], v[176:179], v[212:215], v[32:35]
    v_exp_f32 v225, v81
    v_mfma_f32_16x16x32_bf16 v[36:39], v[180:183], v[212:215], v[36:39]
    v_exp_f32 v226, v82
    v_mfma_f32_16x16x32_bf16 v[4:7], v[180:183], v[208:211], v[4:7]
    ds_read_b64_tr_b16 v[176:177], v235 offset:0
    v_cvt_pk_bf16_f32 v216, v224, v225
    v_mfma_f32_16x16x32_bf16 v[8:11], v[184:187], v[208:211], v[8:11]
    ds_read_b64_tr_b16 v[178:179], v235 offset:512
    v_exp_f32 v227, v83
    v_mfma_f32_16x16x32_bf16 v[40:43], v[184:187], v[212:215], v[40:43]
    s_add_u32 s72, s72, 16640
    ds_read_b64_tr_b16 v[180:181], v235 offset:32
    v_exp_f32 v228, v84
    v_mfma_f32_16x16x32_bf16 v[44:47], v[188:191], v[212:215], v[44:47]
    s_cmp_eq_u32 s72, 149760
    ds_read_b64_tr_b16 v[182:183], v235 offset:544
    v_cvt_pk_bf16_f32 v217, v226, v227
    v_mfma_f32_16x16x32_bf16 v[12:15], v[188:191], v[208:211], v[12:15]
    s_cselect_b32 s72, 0, s72
    ds_read_b64_tr_b16 v[184:185], v235 offset:64
    v_exp_f32 v229, v85
    v_mfma_f32_16x16x32_bf16 v[16:19], v[192:195], v[208:211], v[16:19]
    ds_read_b64_tr_b16 v[186:187], v235 offset:576
    v_exp_f32 v230, v86
    v_mfma_f32_16x16x32_bf16 v[48:51], v[192:195], v[212:215], v[48:51]
    ds_read_b64_tr_b16 v[188:189], v235 offset:96
    v_cvt_pk_bf16_f32 v218, v228, v229
    v_mfma_f32_16x16x32_bf16 v[52:55], v[196:199], v[212:215], v[52:55]
    ds_read_b64_tr_b16 v[190:191], v235 offset:608
    v_exp_f32 v231, v87
    v_mfma_f32_16x16x32_bf16 v[20:23], v[196:199], v[208:211], v[20:23]
    ds_read_b64_tr_b16 v[192:193], v235 offset:128
    v_or3_b32 v249, v216, v217, v218
    v_mfma_f32_16x16x32_bf16 v[24:27], v[200:203], v[208:211], v[24:27]
    v_exp_f32 v224, v88
    v_mfma_f32_16x16x32_bf16 v[56:59], v[200:203], v[212:215], v[56:59]
    ds_read_b64_tr_b16 v[194:195], v235 offset:640
    v_cvt_pk_bf16_f32 v219, v230, v231
    v_mfma_f32_16x16x32_bf16 v[60:63], v[204:207], v[212:215], v[60:63]
    v_exp_f32 v225, v89
    v_mfma_f32_16x16x32_bf16 v[28:31], v[204:207], v[208:211], v[28:31]
    ds_read_b64_tr_b16 v[196:197], v235 offset:160
    ds_read_b64_tr_b16 v[198:199], v235 offset:672
    v_mfma_f32_16x16x32_bf16 v[240:243], v[104:107], v[208:211], v[240:243]
    v_exp_f32 v226, v90
    v_mfma_f32_16x16x32_bf16 v[244:247], v[104:107], v[212:215], v[244:247]
    ds_read_b64_tr_b16 v[200:201], v235 offset:192
    v_cvt_pk_bf16_f32 v220, v224, v225
    v_exp_f32 v227, v91
    ds_read_b64_tr_b16 v[202:203], v235 offset:704
    v_or3_b32 v249, v249, v219, v220
    ds_read_b64_tr_b16 v[204:205], v235 offset:224
    v_exp_f32 v228, v92
    ds_read_b64_tr_b16 v[206:207], v235 offset:736
    v_cvt_pk_bf16_f32 v221, v226, v227
    v_exp_f32 v229, v93
    v_exp_f32 v230, v94
    s_nop 0
    v_cvt_pk_bf16_f32 v222, v228, v229
    v_exp_f32 v231, v95
    v_or3_b32 v249, v249, v221, v222
    v_add_u32 v234, s72, v232
    s_nop 0
    v_cvt_pk_bf16_f32 v223, v230, v231
    v_bitop3_b32 v249, v249, v223, s74 bitop3:0xa8
    v_cmp_ne_u32 vcc, 0, v249
    v_add_u32 v235, s72, v233
    s_cbranch_vccnz L_rare_b3
L_back_b3:
    s_waitcnt lgkmcnt(0)
    s_cmp_eq_u32 s58, 0
    s_cbranch_scc0 L_split1
    v_mfma_f32_16x16x32_bf16 v[240:243], v[104:107], v[216:219], v[240:243]
    v_mfma_f32_16x16x32_bf16 v[244:247], v[104:107], v[220:223], v[244:247]
    v_mfma_f32_16x16x32_bf16 v[0:3], v[176:179], v[216:219], v[0:3]
    v_mfma_f32_16x16x32_bf16 v[4:7], v[180:183], v[216:219], v[4:7]
    v_mfma_f32_16x16x32_bf16 v[8:11], v[184:187], v[216:219], v[8:11]
    v_mfma_f32_16x16x32_bf16 v[12:15], v[188:191], v[216:219], v[12:15]
    v_mfma_f32_16x16x32_bf16 v[16:19], v[192:195], v[216:219], v[16:19]
    v_mfma_f32_16x16x32_bf16 v[20:23], v[196:199], v[216:219], v[20:23]
    v_mfma_f32_16x16x32_bf16 v[24:27], v[200:203], v[216:219], v[24:27]
    v_mfma_f32_16x16x32_bf16 v[28:31], v[204:207], v[216:219], v[28:31]
    v_mfma_f32_16x16x32_bf16 v[32:35], v[176:179], v[220:223], v[32:35]
    v_mfma_f32_16x16x32_bf16 v[36:39], v[180:183], v[220:223], v[36:39]
    v_mfma_f32_16x16x32_bf16 v[40:43], v[184:187], v[220:223], v[40:43]
    v_mfma_f32_16x16x32_bf16 v[44:47], v[188:191], v[220:223], v[44:47]
    v_mfma_f32_16x16x32_bf16 v[48:51], v[192:195], v[220:223], v[48:51]
    v_mfma_f32_16x16x32_bf16 v[52:55], v[196:199], v[220:223], v[52:55]
    v_mfma_f32_16x16x32_bf16 v[56:59], v[200:203], v[220:223], v[56:59]
    v_mfma_f32_16x16x32_bf16 v[60:63], v[204:207], v[220:223], v[60:63]
    v_mov_b32 v208, v96
    v_mov_b32 v209, v240
    v_mov_b32 v210, v100
    v_mov_b32 v211, v244
    buffer_store_dwordx4 v[208:211], v248, s[44:47], s12 offen sc1
    v_cvt_pk_bf16_f32 v144, v0, v1
    v_cvt_pk_bf16_f32 v145, v2, v3
    v_cvt_pk_bf16_f32 v146, v4, v5
    v_cvt_pk_bf16_f32 v147, v6, v7
    buffer_store_dwordx4 v[144:147], v248, s[44:47], s10 offen offset:0 sc1
    v_cvt_pk_bf16_f32 v148, v8, v9
    v_cvt_pk_bf16_f32 v149, v10, v11
    v_cvt_pk_bf16_f32 v150, v12, v13
    v_cvt_pk_bf16_f32 v151, v14, v15
    buffer_store_dwordx4 v[148:151], v248, s[44:47], s10 offen offset:1024 sc1
    v_cvt_pk_bf16_f32 v152, v16, v17
    v_cvt_pk_bf16_f32 v153, v18, v19
    v_cvt_pk_bf16_f32 v154, v20, v21
    v_cvt_pk_bf16_f32 v155, v22, v23
    buffer_store_dwordx4 v[152:155], v248, s[44:47], s10 offen offset:2048 sc1
    v_cvt_pk_bf16_f32 v156, v24, v25
    v_cvt_pk_bf16_f32 v157, v26, v27
    v_cvt_pk_bf16_f32 v158, v28, v29
    v_cvt_pk_bf16_f32 v159, v30, v31
    buffer_store_dwordx4 v[156:159], v248, s[44:47], s10 offen offset:3072 sc1
    v_cvt_pk_bf16_f32 v160, v32, v33
    v_cvt_pk_bf16_f32 v161, v34, v35
    v_cvt_pk_bf16_f32 v162, v36, v37
    v_cvt_pk_bf16_f32 v163, v38, v39
    buffer_store_dwordx4 v[160:163], v248, s[44:47], s11 offen offset:0 sc1
    v_cvt_pk_bf16_f32 v164, v40, v41
    v_cvt_pk_bf16_f32 v165, v42, v43
    v_cvt_pk_bf16_f32 v166, v44, v45
    v_cvt_pk_bf16_f32 v167, v46, v47
    buffer_store_dwordx4 v[164:167], v248, s[44:47], s11 offen offset:1024 sc1
    v_cvt_pk_bf16_f32 v168, v48, v49
    v_cvt_pk_bf16_f32 v169, v50, v51
    v_cvt_pk_bf16_f32 v170, v52, v53
    v_cvt_pk_bf16_f32 v171, v54, v55
    buffer_store_dwordx4 v[168:171], v248, s[44:47], s11 offen offset:2048 sc1
    v_cvt_pk_bf16_f32 v172, v56, v57
    v_cvt_pk_bf16_f32 v173, v58, v59
    v_cvt_pk_bf16_f32 v174, v60, v61
    v_cvt_pk_bf16_f32 v175, v62, v63
    buffer_store_dwordx4 v[172:175], v248, s[44:47], s11 offen offset:3072 sc1
    s_barrier
    s_add_u32 m0, s75, 0
    s_and_b32 s17, s17, 0x1fffff
    buffer_load_dwordx4 v109, s[36:39], s17 offen lds
    s_add_u32 s17, s17, 32768
    s_add_u32 m0, s75, 1024
    s_and_b32 s17, s17, 0x1fffff
    buffer_load_dwordx4 v109, s[36:39], s17 offen lds
    s_add_u32 s17, s17, 32768
    s_add_u32 m0, s75, 2048
    s_and_b32 s17, s17, 0x1fffff
    buffer_load_dwordx4 v109, s[36:39], s17 offen lds
    s_add_u32 s17, s17, 32768
    s_add_u32 m0, s75, 3072
    s_and_b32 s17, s17, 0x1fffff
    buffer_load_dwordx4 v109, s[36:39], s17 offen lds
    s_add_u32 s17, s17, 32768
    s_lshl_b32 s6, s53, 2
    s_add_u32 s6, s6, s55
    s_lshl_b32 s7, s6, 15
    s_lshl_b32 s6, s6, 2
    s_add_u32 s6, s6, s52
    s_lshl_b32 s6, s6, 7
    s_add_u32 s6, s6, 0x2020000
    s_lshl_b32 s63, s56, 8
    s_add_u32 s7, s7, s63
    s_lshl_b32 s63, s52, 6
    s_add_u32 s7, s7, s63
    s_lshl_b32 s10, s53, 7
    s_lshl_b32 s63, s55, 3
    s_add_u32 s10, s10, s63
    s_lshl_b32 s63, s52, 1
    s_add_u32 s10, s10, s63
    s_lshl_b32 s10, s10, 12
    s_add_u32 s10, s10, 0x400000
    s_sub_u32 s63, s63, s53
    s_and_b32 s4, s63, 7
    s_lshl_b32 s4, s4, 12
    s_add_u32 s5, s63, 1
    s_and_b32 s5, s5, 7
    s_lshl_b32 s5, s5, 12
    s_lshl_b32 s11, s53, 3
    s_add_u32 s11, s11, s56
    s_lshl_b32 s11, s11, 2
    s_add_u32 s11, s11, s52
    s_lshl_b32 s11, s11, 15
    s_add_u32 s11, s11, 0x1000000
    s_lshl_b32 s63, s55, 11
    s_add_u32 s12, s11, s63
    s_lshl_b32 s63, s55, 13
    s_add_u32 s11, s11, s63
    s_mul_i32 s14, s56, 11
    s_lshr_b32 s14, s14, 5
    s_mul_i32 s14, s14, 3
    s_sub_u32 s73, s56, s14
    s_add_u32 s9, s55, s73
    s_add_u32 s9, s9, 1
    s_and_b32 s9, s9, 3
    s_lshl_b32 s14, s9, 17
    s_add_u32 s20, s14, s10
    s_lshl_b32 s14, s9, 13
    s_add_u32 s48, s14, s12
    s_sub_u32 s9, s55, s73
    s_sub_u32 s9, s9, 1
    s_and_b32 s9, s9, 3
    s_lshl_b32 s14, s9, 11
    s_add_u32 s18, s14, s11
    s_add_u32 s73, s73, 1
    s_cmp_eq_u32 s73, 3
    s_cselect_b32 s73, 0, s73
    s_add_u32 s9, s55, s73
    s_add_u32 s9, s9, 1
    s_and_b32 s9, s9, 3
    s_lshl_b32 s14, s9, 17
    s_add_u32 s21, s14, s10
    s_lshl_b32 s14, s9, 13
    s_add_u32 s49, s14, s12
    s_sub_u32 s9, s55, s73
    s_sub_u32 s9, s9, 1
    s_and_b32 s9, s9, 3
    s_lshl_b32 s14, s9, 11
    s_add_u32 s16, s14, s11
    s_add_u32 s73, s73, 1
    s_cmp_eq_u32 s73, 3
    s_cselect_b32 s73, 0, s73
    s_add_u32 s9, s55, s73
    s_add_u32 s9, s9, 1
    s_and_b32 s9, s9, 3
    s_lshl_b32 s14, s9, 17
    s_add_u32 s22, s14, s10
    s_lshl_b32 s14, s9, 13
    s_add_u32 s50, s14, s12
    s_sub_u32 s9, s55, s73
    s_sub_u32 s9, s9, 1
    s_and_b32 s9, s9, 3
    s_lshl_b32 s14, s9, 11
    s_add_u32 s15, s14, s11
    s_lshl_b32 s14, s55, 17
    s_add_u32 s23, s14, s10
    s_mov_b32 s19, 0xffffff00
    s_and_b32 s14, s59, 0xff
    v_mov_b32 v56, s14
    s_lshr_b32 s14, s59, 8
    s_xor_b32 s14, s14, s59
    s_and_b32 s14, s14, 0xff
    v_mov_b32 v57, s14
    s_lshr_b32 s14, s59, 16
    s_xor_b32 s14, s14, s59
    s_and_b32 s14, s14, 0xff
    v_mov_b32 v58, s14
    s_lshr_b32 s14, s59, 24
    s_xor_b32 s14, s14, s59
    s_and_b32 s14, s14, 0xff
    v_mov_b32 v59, s14
    v_add_u32 v252, 65536, v248
    v_add_u32 v254, 4096, v248
    s_waitcnt vmcnt(4)
    v_mov_b32 v250, s59
    v_mov_b32 v251, 0
    s_mov_b64 exec, 1
    buffer_store_dword v250, v251, s[44:47], s13 offen sc1
    s_mov_b64 exec, -1
    s_call_b64 s[60:61], L_wo_main
    s_waitcnt vmcnt(11)
    ds_read_b64_tr_b16 a[208:209], v111 offset:7168
    ds_read_b64_tr_b16 a[212:213], v111 offset:7176
    s_waitcnt vmcnt(10)
    ds_read_b64_tr_b16 a[210:211], v111 offset:8192
    ds_read_b64_tr_b16 a[214:215], v111 offset:8200
    s_waitcnt vmcnt(9)
    ds_read_b64_tr_b16 a[216:217], v111 offset:9216
    ds_read_b64_tr_b16 a[220:221], v111 offset:9224
    s_waitcnt vmcnt(8)
    ds_read_b64_tr_b16 a[218:219], v111 offset:10240
    ds_read_b64_tr_b16 a[222:223], v111 offset:10248
    s_waitcnt vmcnt(7)
    ds_read_b64_tr_b16 a[224:225], v111 offset:11264
    ds_read_b64_tr_b16 a[228:229], v111 offset:11272
    s_waitcnt vmcnt(6)
    ds_read_b64_tr_b16 a[226:227], v111 offset:12288
    ds_read_b64_tr_b16 a[230:231], v111 offset:12296
    s_waitcnt vmcnt(5)
    ds_read_b64_tr_b16 a[232:233], v111 offset:13312
    ds_read_b64_tr_b16 a[236:237], v111 offset:13320
    s_waitcnt vmcnt(4)
    ds_read_b64_tr_b16 a[234:235], v111 offset:14336
    ds_read_b64_tr_b16 a[238:239], v111 offset:14344
    s_waitcnt vmcnt(3)
    ds_read_b64_tr_b16 a[240:241], v111 offset:0
    ds_read_b64_tr_b16 a[244:245], v111 offset:8
    s_waitcnt vmcnt(2)
    ds_read_b64_tr_b16 a[242:243], v111 offset:1024
    ds_read_b64_tr_b16 a[246:247], v111 offset:1032
    s_waitcnt vmcnt(1)
    ds_read_b64_tr_b16 a[248:249], v111 offset:2048
    ds_read_b64_tr_b16 a[252:253], v111 offset:2056
    s_waitcnt vmcnt(0)
    ds_read_b64_tr_b16 a[250:251], v111 offset:3072
    ds_read_b64_tr_b16 a[254:255], v111 offset:3080
    s_waitcnt lgkmcnt(0)
    s_barrier
    s_branch L_phase_o
L_split1:
    s_cmp_eq_u32 s77, 1
    s_cbranch_scc1 L_have_partial
    s_mov_b32 s73, 0
L_poll_p:
    s_buffer_load_dword s32, s[44:47], s13 glc
    s_add_u32 s73, s73, 1
    s_cmp_gt_u32 s73, 200000
    s_waitcnt lgkmcnt(0)
    s_cbranch_scc1 L_polled_p
    s_cmp_eq_u32 s32, s59
    s_cbranch_scc0 L_poll_p
L_polled_p:
    buffer_load_dwordx4 v[144:147], v248, s[44:47], s12 offen sc1
    buffer_load_dwordx4 v[112:115], v248, s[44:47], s10 offen offset:0 sc1
    buffer_load_dwordx4 v[116:119], v248, s[44:47], s10 offen offset:1024 sc1
    buffer_load_dwordx4 v[120:123], v248, s[44:47], s10 offen offset:2048 sc1
    buffer_load_dwordx4 v[124:127], v248, s[44:47], s10 offen offset:3072 sc1
    buffer_load_dwordx4 v[128:131], v248, s[44:47], s11 offen offset:0 sc1
    buffer_load_dwordx4 v[132:135], v248, s[44:47], s11 offen offset:1024 sc1
    buffer_load_dwordx4 v[136:139], v248, s[44:47], s11 offen offset:2048 sc1
    buffer_load_dwordx4 v[140:143], v248, s[44:47], s11 offen offset:3072 sc1
L_have_partial:
    v_mfma_f32_16x16x32_bf16 v[240:243], v[104:107], v[216:219], v[240:243]
    s_waitcnt vmcnt(8)
    v_min_f32 v68, v144, v96
    v_min_f32 v69, v146, v100
    v_mfma_f32_16x16x32_bf16 v[244:247], v[104:107], v[220:223], v[244:247]
    s_lshr_b32 s62, s57, 2
    v_sub_f32 v64, v68, v144
    v_sub_f32 v66, v69, v146
    v_mfma_f32_16x16x32_bf16 v[0:3], v[176:179], v[216:219], v[0:3]
    s_lshl_b32 s62, s62, 2
    v_sub_f32 v65, v68, v96
    v_sub_f32 v67, v69, v100
    v_mfma_f32_16x16x32_bf16 v[4:7], v[180:183], v[216:219], v[4:7]
    s_add_u32 s62, s62, s55
    v_exp_f32 v64, v64
    v_exp_f32 v66, v66
    v_mfma_f32_16x16x32_bf16 v[8:11], v[184:187], v[216:219], v[8:11]
    s_lshl_b32 s62, s62, 2
    v_exp_f32 v65, v65
    v_exp_f32 v67, v67
    v_mfma_f32_16x16x32_bf16 v[12:15], v[188:191], v[216:219], v[12:15]
    s_add_u32 s62, s62, s52
    v_mul_f32 v68, v145, v64
    v_mul_f32 v69, v147, v66
    v_mfma_f32_16x16x32_bf16 v[16:19], v[192:195], v[216:219], v[16:19]
    s_lshl_b32 s62, s62, 7
    v_fmac_f32 v68, v240, v65
    v_fmac_f32 v69, v244, v67
    v_mfma_f32_16x16x32_bf16 v[20:23], v[196:199], v[216:219], v[20:23]
    s_and_b32 s63, s57, 3
    v_rcp_f32 v68, v68
    v_rcp_f32 v69, v69
    v_mfma_f32_16x16x32_bf16 v[24:27], v[200:203], v[216:219], v[24:27]
    s_lshl_b32 s63, s63, 2
    v_mul_f32 v64, v64, v68
    v_mul_f32 v66, v66, v69
    v_mfma_f32_16x16x32_bf16 v[28:31], v[204:207], v[216:219], v[28:31]
    s_add_u32 s62, s62, s63
    v_mul_f32 v65, v65, v68
    v_mul_f32 v67, v67, v69
    v_mfma_f32_16x16x32_bf16 v[32:35], v[176:179], v[220:223], v[32:35]
    s_waitcnt vmcnt(6)
    v_lshlrev_b32 v80, 16, v112
    v_and_b32 v81, 0xffff0000, v112
    v_mfma_f32_16x16x32_bf16 v[36:39], v[180:183], v[220:223], v[36:39]
    s_add_u32 s62, s62, 0x2020000
    v_lshlrev_b32 v82, 16, v113
    v_and_b32 v83, 0xffff0000, v113
    v_mfma_f32_16x16x32_bf16 v[40:43], v[184:187], v[220:223], v[40:43]
    s_add_u32 s64, s8, 0x400000
    v_lshlrev_b32 v84, 16, v114
    v_and_b32 v85, 0xffff0000, v114
    v_mfma_f32_16x16x32_bf16 v[44:47], v[188:191], v[220:223], v[44:47]
    s_add_u32 s65, s64, 4096
    v_lshlrev_b32 v86, 16, v115
    v_and_b32 v87, 0xffff0000, v115
    v_mfma_f32_16x16x32_bf16 v[48:51], v[192:195], v[220:223], v[48:51]
    v_lshlrev_b32 v88, 16, v116
    v_and_b32 v89, 0xffff0000, v116
    v_mfma_f32_16x16x32_bf16 v[52:55], v[196:199], v[220:223], v[52:55]
    v_lshlrev_b32 v90, 16, v117
    v_and_b32 v91, 0xffff0000, v117
    v_mfma_f32_16x16x32_bf16 v[56:59], v[200:203], v[220:223], v[56:59]
    v_lshlrev_b32 v92, 16, v118
    v_and_b32 v93, 0xffff0000, v118
    v_mfma_f32_16x16x32_bf16 v[60:63], v[204:207], v[220:223], v[60:63]
    v_lshlrev_b32 v94, 16, v119
    v_and_b32 v95, 0xffff0000, v119
    v_pk_mul_f32 v[0:1], v[0:1], v[64:65] op_sel:[0,1] op_sel_hi:[1,1]
    v_pk_mul_f32 v[2:3], v[2:3], v[64:65] op_sel:[0,1] op_sel_hi:[1,1]
    v_pk_mul_f32 v[4:5], v[4:5], v[64:65] op_sel:[0,1] op_sel_hi:[1,1]
    v_pk_mul_f32 v[6:7], v[6:7], v[64:65] op_sel:[0,1] op_sel_hi:[1,1]
    v_pk_fma_f32 v[0:1], v[80:81], v[64:65], v[0:1] op_sel:[0,0,0] op_sel_hi:[1,0,1]
    v_pk_fma_f32 v[2:3], v[82:83], v[64:65], v[2:3] op_sel:[0,0,0] op_sel_hi:[1,0,1]
    v_pk_fma_f32 v[4:5], v[84:85], v[64:65], v[4:5] op_sel:[0,0,0] op_sel_hi:[1,0,1]
    v_pk_fma_f32 v[6:7], v[86:87], v[64:65], v[6:7] op_sel:[0,0,0] op_sel_hi:[1,0,1]
    v_cvt_pk_bf16_f32 v148, v0, v1
    v_cvt_pk_bf16_f32 v149, v2, v3
    v_cvt_pk_bf16_f32 v150, v4, v5
    v_cvt_pk_bf16_f32 v151, v6, v7
    buffer_store_dwordx4 v[148:151], v248, s[44:47], s64 offen offset:0 sc1
    s_waitcnt vmcnt(6)
    v_lshlrev_b32 v80, 16, v120
    v_and_b32 v81, 0xffff0000, v120
    v_lshlrev_b32 v82, 16, v121
    v_and_b32 v83, 0xffff0000, v121
    v_lshlrev_b32 v84, 16, v122
    v_and_b32 v85, 0xffff0000, v122
    v_lshlrev_b32 v86, 16, v123
    v_and_b32 v87, 0xffff0000, v123
    v_pk_mul_f32 v[8:9], v[8:9], v[64:65] op_sel:[0,1] op_sel_hi:[1,1]
    v_pk_mul_f32 v[10:11], v[10:11], v[64:65] op_sel:[0,1] op_sel_hi:[1,1]
    v_pk_mul_f32 v[12:13], v[12:13], v[64:65] op_sel:[0,1] op_sel_hi:[1,1]
    v_pk_mul_f32 v[14:15], v[14:15], v[64:65] op_sel:[0,1] op_sel_hi:[1,1]
    v_pk_fma_f32 v[8:9], v[88:89], v[64:65], v[8:9] op_sel:[0,0,0] op_sel_hi:[1,0,1]
    v_pk_fma_f32 v[10:11], v[90:91], v[64:65], v[10:11] op_sel:[0,0,0] op_sel_hi:[1,0,1]
    v_pk_fma_f32 v[12:13], v[92:93], v[64:65], v[12:13] op_sel:[0,0,0] op_sel_hi:[1,0,1]
    v_pk_fma_f32 v[14:15], v[94:95], v[64:65], v[14:15] op_sel:[0,0,0] op_sel_hi:[1,0,1]
    v_cvt_pk_bf16_f32 v152, v8, v9
    v_cvt_pk_bf16_f32 v153, v10, v11
    v_cvt_pk_bf16_f32 v154, v12, v13
    v_cvt_pk_bf16_f32 v155, v14, v15
    buffer_store_dwordx4 v[152:155], v248, s[44:47], s64 offen offset:1024 sc1
    s_waitcnt vmcnt(6)
    v_lshlrev_b32 v88, 16, v124
    v_and_b32 v89, 0xffff0000, v124
    v_lshlrev_b32 v90, 16, v125
    v_and_b32 v91, 0xffff0000, v125
    v_lshlrev_b32 v92, 16, v126
    v_and_b32 v93, 0xffff0000, v126
    v_lshlrev_b32 v94, 16, v127
    v_and_b32 v95, 0xffff0000, v127
    v_pk_mul_f32 v[16:17], v[16:17], v[64:65] op_sel:[0,1] op_sel_hi:[1,1]
    v_pk_mul_f32 v[18:19], v[18:19], v[64:65] op_sel:[0,1] op_sel_hi:[1,1]
    v_pk_mul_f32 v[20:21], v[20:21], v[64:65] op_sel:[0,1] op_sel_hi:[1,1]
    v_pk_mul_f32 v[22:23], v[22:23], v[64:65] op_sel:[0,1] op_sel_hi:[1,1]
    v_pk_fma_f32 v[16:17], v[80:81], v[64:65], v[16:17] op_sel:[0,0,0] op_sel_hi:[1,0,1]
    v_pk_fma_f32 v[18:19], v[82:83], v[64:65], v[18:19] op_sel:[0,0,0] op_sel_hi:[1,0,1]
    v_pk_fma_f32 v[20:21], v[84:85], v[64:65], v[20:21] op_sel:[0,0,0] op_sel_hi:[1,0,1]
    v_pk_fma_f32 v[22:23], v[86:87], v[64:65], v[22:23] op_sel:[0,0,0] op_sel_hi:[1,0,1]
    v_cvt_pk_bf16_f32 v156, v16, v17
    v_cvt_pk_bf16_f32 v157, v18, v19
    v_cvt_pk_bf16_f32 v158, v20, v21
    v_cvt_pk_bf16_f32 v159, v22, v23
    buffer_store_dwordx4 v[156:159], v248, s[44:47], s64 offen offset:2048 sc1
    s_waitcnt vmcnt(6)
    v_lshlrev_b32 v80, 16, v128
    v_and_b32 v81, 0xffff0000, v128
    v_lshlrev_b32 v82, 16, v129
    v_and_b32 v83, 0xffff0000, v129
    v_lshlrev_b32 v84, 16, v130
    v_and_b32 v85, 0xffff0000, v130
    v_lshlrev_b32 v86, 16, v131
    v_and_b32 v87, 0xffff0000, v131
    v_pk_mul_f32 v[24:25], v[24:25], v[64:65] op_sel:[0,1] op_sel_hi:[1,1]
    v_pk_mul_f32 v[26:27], v[26:27], v[64:65] op_sel:[0,1] op_sel_hi:[1,1]
    v_pk_mul_f32 v[28:29], v[28:29], v[64:65] op_sel:[0,1] op_sel_hi:[1,1]
    v_pk_mul_f32 v[30:31], v[30:31], v[64:65] op_sel:[0,1] op_sel_hi:[1,1]
    v_pk_fma_f32 v[24:25], v[88:89], v[64:65], v[24:25] op_sel:[0,0,0] op_sel_hi:[1,0,1]
    v_pk_fma_f32 v[26:27], v[90:91], v[64:65], v[26:27] op_sel:[0,0,0] op_sel_hi:[1,0,1]
    v_pk_fma_f32 v[28:29], v[92:93], v[64:65], v[28:29] op_sel:[0,0,0] op_sel_hi:[1,0,1]
    v_pk_fma_f32 v[30:31], v[94:95], v[64:65], v[30:31] op_sel:[0,0,0] op_sel_hi:[1,0,1]
    v_cvt_pk_bf16_f32 v160, v24, v25
    v_cvt_pk_bf16_f32 v161, v26, v27
    v_cvt_pk_bf16_f32 v162, v28, v29
    v_cvt_pk_bf16_f32 v163, v30, v31
    buffer_store_dwordx4 v[160:163], v248, s[44:47], s64 offen offset:3072 sc1
    s_waitcnt vmcnt(6)
    v_lshlrev_b32 v88, 16, v132
    v_and_b32 v89, 0xffff0000, v132
    v_lshlrev_b32 v90, 16, v133
    v_and_b32 v91, 0xffff0000, v133
    v_lshlrev_b32 v92, 16, v134
    v_and_b32 v93, 0xffff0000, v134
    v_lshlrev_b32 v94, 16, v135
    v_and_b32 v95, 0xffff0000, v135
    v_pk_mul_f32 v[32:33], v[32:33], v[66:67] op_sel:[0,1] op_sel_hi:[1,1]
    v_pk_mul_f32 v[34:35], v[34:35], v[66:67] op_sel:[0,1] op_sel_hi:[1,1]
    v_pk_mul_f32 v[36:37], v[36:37], v[66:67] op_sel:[0,1] op_sel_hi:[1,1]
    v_pk_mul_f32 v[38:39], v[38:39], v[66:67] op_sel:[0,1] op_sel_hi:[1,1]
    v_pk_fma_f32 v[32:33], v[80:81], v[66:67], v[32:33] op_sel:[0,0,0] op_sel_hi:[1,0,1]
    v_pk_fma_f32 v[34:35], v[82:83], v[66:67], v[34:35] op_sel:[0,0,0] op_sel_hi:[1,0,1]
    v_pk_fma_f32 v[36:37], v[84:85], v[66:67], v[36:37] op_sel:[0,0,0] op_sel_hi:[1,0,1]
    v_pk_fma_f32 v[38:39], v[86:87], v[66:67], v[38:39] op_sel:[0,0,0] op_sel_hi:[1,0,1]
    v_cvt_pk_bf16_f32 v164, v32, v33
    v_cvt_pk_bf16_f32 v165, v34, v35
    v_cvt_pk_bf16_f32 v166, v36, v37
    v_cvt_pk_bf16_f32 v167, v38, v39
    buffer_store_dwordx4 v[164:167], v248, s[44:47], s65 offen offset:0 sc1
    s_waitcnt vmcnt(6)
    v_lshlrev_b32 v80, 16, v136
    v_and_b32 v81, 0xffff0000, v136
    v_lshlrev_b32 v82, 16, v137
    v_and_b32 v83, 0xffff0000, v137
    v_lshlrev_b32 v84, 16, v138
    v_and_b32 v85, 0xffff0000, v138
    v_lshlrev_b32 v86, 16, v139
    v_and_b32 v87, 0xffff0000, v139
    v_pk_mul_f32 v[40:41], v[40:41], v[66:67] op_sel:[0,1] op_sel_hi:[1,1]
    v_pk_mul_f32 v[42:43], v[42:43], v[66:67] op_sel:[0,1] op_sel_hi:[1,1]
    v_pk_mul_f32 v[44:45], v[44:45], v[66:67] op_sel:[0,1] op_sel_hi:[1,1]
    v_pk_mul_f32 v[46:47], v[46:47], v[66:67] op_sel:[0,1] op_sel_hi:[1,1]
    v_pk_fma_f32 v[40:41], v[88:89], v[66:67], v[40:41] op_sel:[0,0,0] op_sel_hi:[1,0,1]
    v_pk_fma_f32 v[42:43], v[90:91], v[66:67], v[42:43] op_sel:[0,0,0] op_sel_hi:[1,0,1]
    v_pk_fma_f32 v[44:45], v[92:93], v[66:67], v[44:45] op_sel:[0,0,0] op_sel_hi:[1,0,1]
    v_pk_fma_f32 v[46:47], v[94:95], v[66:67], v[46:47] op_sel:[0,0,0] op_sel_hi:[1,0,1]
    v_cvt_pk_bf16_f32 v168, v40, v41
    v_cvt_pk_bf16_f32 v169, v42, v43
    v_cvt_pk_bf16_f32 v170, v44, v45
    v_cvt_pk_bf16_f32 v171, v46, v47
    buffer_store_dwordx4 v[168:171], v248, s[44:47], s65 offen offset:1024 sc1
    s_waitcnt vmcnt(6)
    v_lshlrev_b32 v88, 16, v140
    v_and_b32 v89, 0xffff0000, v140
    v_lshlrev_b32 v90, 16, v141
    v_and_b32 v91, 0xffff0000, v141
    v_lshlrev_b32 v92, 16, v142
    v_and_b32 v93, 0xffff0000, v142
    v_lshlrev_b32 v94, 16, v143
    v_and_b32 v95, 0xffff0000, v143
    v_pk_mul_f32 v[48:49], v[48:49], v[66:67] op_sel:[0,1] op_sel_hi:[1,1]
    v_pk_mul_f32 v[50:51], v[50:51], v[66:67] op_sel:[0,1] op_sel_hi:[1,1]
    v_pk_mul_f32 v[52:53], v[52:53], v[66:67] op_sel:[0,1] op_sel_hi:[1,1]
    v_pk_mul_f32 v[54:55], v[54:55], v[66:67] op_sel:[0,1] op_sel_hi:[1,1]
    v_pk_fma_f32 v[48:49], v[80:81], v[66:67], v[48:49] op_sel:[0,0,0] op_sel_hi:[1,0,1]
    v_pk_fma_f32 v[50:51], v[82:83], v[66:67], v[50:51] op_sel:[0,0,0] op_sel_hi:[1,0,1]
    v_pk_fma_f32 v[52:53], v[84:85], v[66:67], v[52:53] op_sel:[0,0,0] op_sel_hi:[1,0,1]
    v_pk_fma_f32 v[54:55], v[86:87], v[66:67], v[54:55] op_sel:[0,0,0] op_sel_hi:[1,0,1]
    v_cvt_pk_bf16_f32 v172, v48, v49
    v_cvt_pk_bf16_f32 v173, v50, v51
    v_cvt_pk_bf16_f32 v174, v52, v53
    v_cvt_pk_bf16_f32 v175, v54, v55
    buffer_store_dwordx4 v[172:175], v248, s[44:47], s65 offen offset:2048 sc1
    v_pk_mul_f32 v[56:57], v[56:57], v[66:67] op_sel:[0,1] op_sel_hi:[1,1]
    v_pk_mul_f32 v[58:59], v[58:59], v[66:67] op_sel:[0,1] op_sel_hi:[1,1]
    v_pk_mul_f32 v[60:61], v[60:61], v[66:67] op_sel:[0,1] op_sel_hi:[1,1]
    v_pk_mul_f32 v[62:63], v[62:63], v[66:67] op_sel:[0,1] op_sel_hi:[1,1]
    v_pk_fma_f32 v[56:57], v[88:89], v[66:67], v[56:57] op_sel:[0,0,0] op_sel_hi:[1,0,1]
    v_pk_fma_f32 v[58:59], v[90:91], v[66:67], v[58:59] op_sel:[0,0,0] op_sel_hi:[1,0,1]
    v_pk_fma_f32 v[60:61], v[92:93], v[66:67], v[60:61] op_sel:[0,0,0] op_sel_hi:[1,0,1]
    v_pk_fma_f32 v[62:63], v[94:95], v[66:67], v[62:63] op_sel:[0,0,0] op_sel_hi:[1,0,1]
    v_cvt_pk_bf16_f32 v148, v56, v57
    v_cvt_pk_bf16_f32 v149, v58, v59
    v_cvt_pk_bf16_f32 v150, v60, v61
    v_cvt_pk_bf16_f32 v151, v62, v63
    buffer_store_dwordx4 v[148:151], v248, s[44:47], s65 offen offset:3072 sc1
    s_lshl_b32 s6, s53, 2
    s_add_u32 s6, s6, s55
    s_lshl_b32 s7, s6, 15
    s_lshl_b32 s6, s6, 2
    s_add_u32 s6, s6, s52
    s_lshl_b32 s6, s6, 7
    s_add_u32 s6, s6, 0x2020000
    s_lshl_b32 s63, s56, 8
    s_add_u32 s7, s7, s63
    s_lshl_b32 s63, s52, 6
    s_add_u32 s7, s7, s63
    s_lshl_b32 s10, s53, 7
    s_lshl_b32 s63, s55, 3
    s_add_u32 s10, s10, s63
    s_lshl_b32 s63, s52, 1
    s_add_u32 s10, s10, s63
    s_lshl_b32 s10, s10, 12
    s_add_u32 s10, s10, 0x400000
    s_sub_u32 s63, s63, s53
    s_and_b32 s4, s63, 7
    s_lshl_b32 s4, s4, 12
    s_add_u32 s5, s63, 1
    s_and_b32 s5, s5, 7
    s_lshl_b32 s5, s5, 12
    s_lshl_b32 s11, s53, 3
    s_add_u32 s11, s11, s56
    s_lshl_b32 s11, s11, 2
    s_add_u32 s11, s11, s52
    s_lshl_b32 s11, s11, 15
    s_add_u32 s11, s11, 0x1000000
    s_lshl_b32 s63, s55, 11
    s_add_u32 s12, s11, s63
    s_lshl_b32 s63, s55, 13
    s_add_u32 s11, s11, s63
    s_mul_i32 s14, s56, 11
    s_lshr_b32 s14, s14, 5
    s_mul_i32 s14, s14, 3
    s_sub_u32 s73, s56, s14
    s_add_u32 s9, s55, s73
    s_add_u32 s9, s9, 1
    s_and_b32 s9, s9, 3
    s_lshl_b32 s14, s9, 17
    s_add_u32 s20, s14, s10
    s_lshl_b32 s14, s9, 13
    s_add_u32 s48, s14, s12
    s_sub_u32 s9, s55, s73
    s_sub_u32 s9, s9, 1
    s_and_b32 s9, s9, 3
    s_lshl_b32 s14, s9, 11
    s_add_u32 s18, s14, s11
    s_add_u32 s73, s73, 1
    s_cmp_eq_u32 s73, 3
    s_cselect_b32 s73, 0, s73
    s_add_u32 s9, s55, s73
    s_add_u32 s9, s9, 1
    s_and_b32 s9, s9, 3
    s_lshl_b32 s14, s9, 17
    s_add_u32 s21, s14, s10
    s_lshl_b32 s14, s9, 13
    s_add_u32 s49, s14, s12
    s_sub_u32 s9, s55, s73
    s_sub_u32 s9, s9, 1
    s_and_b32 s9, s9, 3
    s_lshl_b32 s14, s9, 11
    s_add_u32 s16, s14, s11
    s_add_u32 s73, s73, 1
    s_cmp_eq_u32 s73, 3
    s_cselect_b32 s73, 0, s73
    s_add_u32 s9, s55, s73
    s_add_u32 s9, s9, 1
    s_and_b32 s9, s9, 3
    s_lshl_b32 s14, s9, 17
    s_add_u32 s22, s14, s10
    s_lshl_b32 s14, s9, 13
    s_add_u32 s50, s14, s12
    s_sub_u32 s9, s55, s73
    s_sub_u32 s9, s9, 1
    s_and_b32 s9, s9, 3
    s_lshl_b32 s14, s9, 11
    s_add_u32 s15, s14, s11
    s_lshl_b32 s14, s55, 17
    s_add_u32 s23, s14, s10
    s_mov_b32 s19, 0xffffff00
    s_and_b32 s14, s59, 0xff
    v_mov_b32 v56, s14
    s_lshr_b32 s14, s59, 8
    s_xor_b32 s14, s14, s59
    s_and_b32 s14, s14, 0xff
    v_mov_b32 v57, s14
    s_lshr_b32 s14, s59, 16
    s_xor_b32 s14, s14, s59
    s_and_b32 s14, s14, 0xff
    v_mov_b32 v58, s14
    s_lshr_b32 s14, s59, 24
    s_xor_b32 s14, s14, s59
    s_and_b32 s14, s14, 0xff
    v_mov_b32 v59, s14
    v_add_u32 v252, 65536, v248
    v_add_u32 v254, 4096, v248
    s_waitcnt vmcnt(0)
    v_mov_b32 v250, s59
    v_mov_b32 v251, 0
    s_mov_b64 exec, 1
    buffer_store_dword v250, v251, s[44:47], s62 offen sc1
    s_mov_b64 exec, -1
    s_barrier
L_phase_o:
    s_mov_b32 s73, 0
L_poll_o:
    s_buffer_load_dwordx4 s[32:35], s[44:47], s6 glc
    s_add_u32 s73, s73, 1
    s_cmp_gt_u32 s73, 200000
    s_waitcnt lgkmcnt(0)
    s_cbranch_scc1 L_polled_o
    s_xor_b32 s32, s32, s59
    s_xor_b32 s33, s33, s59
    s_xor_b32 s34, s34, s59
    s_xor_b32 s35, s35, s59
    s_or_b64 s[32:33], s[32:33], s[34:35]
    s_cmp_eq_u64 s[32:33], 0
    s_cbranch_scc0 L_poll_o
L_polled_o:
    s_add_u32 m0, s4, 0
    s_nop 0
    buffer_load_dwordx4 v248, s[44:47], s20 offen offset:0 sc1 lds
    buffer_load_dwordx4 v248, s[44:47], s20 offen offset:1024 sc1 lds
    buffer_load_dwordx4 v248, s[44:47], s20 offen offset:2048 sc1 lds
    buffer_load_dwordx4 v248, s[44:47], s20 offen offset:3072 sc1 lds
    s_add_u32 m0, s5, 0
    s_nop 0
    buffer_load_dwordx4 v254, s[44:47], s20 offen offset:0 sc1 lds
    buffer_load_dwordx4 v254, s[44:47], s20 offen offset:1024 sc1 lds
    buffer_load_dwordx4 v254, s[44:47], s20 offen offset:2048 sc1 lds
    buffer_load_dwordx4 v254, s[44:47], s20 offen offset:3072 sc1 lds
    s_add_u32 m0, s4, 32768
    s_nop 0
    buffer_load_dwordx4 v248, s[44:47], s21 offen offset:0 sc1 lds
    buffer_load_dwordx4 v248, s[44:47], s21 offen offset:1024 sc1 lds
    s_waitcnt vmcnt(2)
    s_barrier
    ds_read_b128 v[128:131], v248 offset:0
    ds_read_b128 v[132:135], v248 offset:1024
    ds_read_b128 v[136:139], v248 offset:2048
    ds_read_b128 v[140:143], v248 offset:3072
    ds_read_b128 v[144:147], v248 offset:4096
    ds_read_b128 v[148:151], v248 offset:5120
    s_waitcnt lgkmcnt(4)
    v_mfma_f32_16x16x32_bf16 v[0:3], a[0:3], v[128:131], 0
    ds_read_b128 v[152:155], v248 offset:6144
    v_mfma_f32_16x16x32_bf16 v[4:7], a[4:7], v[128:131], 0
    buffer_load_dwordx4 v248, s[44:47], s21 offen offset:2048 sc1 lds
    v_mfma_f32_16x16x32_bf16 v[0:3], a[8:11], v[132:135], v[0:3]
    ds_read_b128 v[156:159], v248 offset:7168
    v_mfma_f32_16x16x32_bf16 v[4:7], a[12:15], v[132:135], v[4:7]
    s_waitcnt lgkmcnt(4)
    buffer_load_dwordx4 v248, s[44:47], s21 offen offset:3072 sc1 lds
    v_mfma_f32_16x16x32_bf16 v[0:3], a[16:19], v[136:139], v[0:3]
    s_add_u32 m0, s5, 32768
    ds_read_b128 v[160:163], v248 offset:8192
    v_mfma_f32_16x16x32_bf16 v[4:7], a[20:23], v[136:139], v[4:7]
    buffer_load_dwordx4 v254, s[44:47], s21 offen offset:0 sc1 lds
    v_mfma_f32_16x16x32_bf16 v[0:3], a[24:27], v[140:143], v[0:3]
    ds_read_b128 v[164:167], v248 offset:9216
    v_mfma_f32_16x16x32_bf16 v[4:7], a[28:31], v[140:143], v[4:7]
    s_waitcnt lgkmcnt(4)
    buffer_load_dwordx4 v254, s[44:47], s21 offen offset:1024 sc1 lds
    v_mfma_f32_16x16x32_bf16 v[0:3], a[32:35], v[144:147], v[0:3]
    ds_read_b128 v[168:171], v248 offset:10240
    v_mfma_f32_16x16x32_bf16 v[4:7], a[36:39], v[144:147], v[4:7]
    buffer_load_dwordx4 v254, s[44:47], s21 offen offset:2048 sc1 lds
    v_mfma_f32_16x16x32_bf16 v[0:3], a[40:43], v[148:151], v[0:3]
    ds_read_b128 v[172:175], v248 offset:11264
    v_mfma_f32_16x16x32_bf16 v[4:7], a[44:47], v[148:151], v[4:7]
    s_waitcnt lgkmcnt(4)
    buffer_load_dwordx4 v254, s[44:47], s21 offen offset:3072 sc1 lds
    v_mfma_f32_16x16x32_bf16 v[0:3], a[48:51], v[152:155], v[0:3]
    ds_read_b128 v[176:179], v248 offset:12288
    v_mfma_f32_16x16x32_bf16 v[4:7], a[52:55], v[152:155], v[4:7]
    v_mfma_f32_16x16x32_bf16 v[0:3], a[56:59], v[156:159], v[0:3]
    ds_read_b128 v[180:183], v248 offset:13312
    v_mfma_f32_16x16x32_bf16 v[4:7], a[60:63], v[156:159], v[4:7]
    s_waitcnt lgkmcnt(4)
    v_mfma_f32_16x16x32_bf16 v[0:3], a[64:67], v[160:163], v[0:3]
    ds_read_b128 v[184:187], v248 offset:14336
    v_mfma_f32_16x16x32_bf16 v[4:7], a[68:71], v[160:163], v[4:7]
    v_mfma_f32_16x16x32_bf16 v[0:3], a[72:75], v[164:167], v[0:3]
    ds_read_b128 v[188:191], v248 offset:15360
    v_mfma_f32_16x16x32_bf16 v[4:7], a[76:79], v[164:167], v[4:7]
    s_waitcnt lgkmcnt(4)
    v_mfma_f32_16x16x32_bf16 v[0:3], a[80:83], v[168:171], v[0:3]
    ds_read_b128 v[128:131], v248 offset:16384
    v_mfma_f32_16x16x32_bf16 v[4:7], a[84:87], v[168:171], v[4:7]
    v_mfma_f32_16x16x32_bf16 v[0:3], a[88:91], v[172:175], v[0:3]
    ds_read_b128 v[132:135], v248 offset:17408
    v_mfma_f32_16x16x32_bf16 v[4:7], a[92:95], v[172:175], v[4:7]
    s_waitcnt lgkmcnt(4)
    v_mfma_f32_16x16x32_bf16 v[0:3], a[96:99], v[176:179], v[0:3]
    s_add_u32 m0, s4, 65536
    ds_read_b128 v[136:139], v248 offset:18432
    v_mfma_f32_16x16x32_bf16 v[4:7], a[100:103], v[176:179], v[4:7]
    buffer_load_dwordx4 v248, s[44:47], s22 offen offset:0 sc1 lds
    v_mfma_f32_16x16x32_bf16 v[0:3], a[104:107], v[180:183], v[0:3]
    ds_read_b128 v[140:143], v248 offset:19456
    v_mfma_f32_16x16x32_bf16 v[4:7], a[108:111], v[180:183], v[4:7]
    s_waitcnt lgkmcnt(4)
    v_mfma_f32_16x16x32_bf16 v[0:3], a[112:115], v[184:187], v[0:3]
    ds_read_b128 v[144:147], v248 offset:20480
    v_mfma_f32_16x16x32_bf16 v[4:7], a[116:119], v[184:187], v[4:7]
    buffer_load_dwordx4 v248, s[44:47], s22 offen offset:1024 sc1 lds
    v_mfma_f32_16x16x32_bf16 v[0:3], a[120:123], v[188:191], v[0:3]
    ds_read_b128 v[148:151], v248 offset:21504
    v_mfma_f32_16x16x32_bf16 v[4:7], a[124:127], v[188:191], v[4:7]
    s_waitcnt lgkmcnt(4)
    v_mfma_f32_16x16x32_bf16 v[0:3], a[128:131], v[128:131], v[0:3]
    ds_read_b128 v[152:155], v248 offset:22528
    v_mfma_f32_16x16x32_bf16 v[4:7], a[132:135], v[128:131], v[4:7]
    buffer_load_dwordx4 v248, s[44:47], s22 offen offset:2048 sc1 lds
    v_mfma_f32_16x16x32_bf16 v[0:3], a[136:139], v[132:135], v[0:3]
    ds_read_b128 v[156:159], v248 offset:23552
    v_mfma_f32_16x16x32_bf16 v[4:7], a[140:143], v[132:135], v[4:7]
    s_waitcnt lgkmcnt(4)
    v_mfma_f32_16x16x32_bf16 v[0:3], a[144:147], v[136:139], v[0:3]
    ds_read_b128 v[160:163], v248 offset:24576
    v_mfma_f32_16x16x32_bf16 v[4:7], a[148:151], v[136:139], v[4:7]
    buffer_load_dwordx4 v248, s[44:47], s22 offen offset:3072 sc1 lds
    v_mfma_f32_16x16x32_bf16 v[0:3], a[152:155], v[140:143], v[0:3]
    ds_read_b128 v[164:167], v248 offset:25600
    v_mfma_f32_16x16x32_bf16 v[4:7], a[156:159], v[140:143], v[4:7]
    s_waitcnt lgkmcnt(4)
    v_mfma_f32_16x16x32_bf16 v[0:3], a[160:163], v[144:147], v[0:3]
    s_add_u32 m0, s5, 65536
    ds_read_b128 v[168:171], v248 offset:26624
    v_mfma_f32_16x16x32_bf16 v[4:7], a[164:167], v[144:147], v[4:7]
    buffer_load_dwordx4 v254, s[44:47], s22 offen offset:0 sc1 lds
    v_mfma_f32_16x16x32_bf16 v[0:3], a[168:171], v[148:151], v[0:3]
    ds_read_b128 v[172:175], v248 offset:27648
    v_mfma_f32_16x16x32_bf16 v[4:7], a[172:175], v[148:151], v[4:7]
    s_waitcnt lgkmcnt(4)
    v_mfma_f32_16x16x32_bf16 v[0:3], a[176:179], v[152:155], v[0:3]
    ds_read_b128 v[176:179], v248 offset:28672
    v_mfma_f32_16x16x32_bf16 v[4:7], a[180:183], v[152:155], v[4:7]
    buffer_load_dwordx4 v254, s[44:47], s22 offen offset:1024 sc1 lds
    v_mfma_f32_16x16x32_bf16 v[0:3], a[184:187], v[156:159], v[0:3]
    ds_read_b128 v[180:183], v248 offset:29696
    v_mfma_f32_16x16x32_bf16 v[4:7], a[188:191], v[156:159], v[4:7]
    s_waitcnt lgkmcnt(4)
    v_mfma_f32_16x16x32_bf16 v[0:3], a[192:195], v[160:163], v[0:3]
    ds_read_b128 v[184:187], v248 offset:30720
    v_mfma_f32_16x16x32_bf16 v[4:7], a[196:199], v[160:163], v[4:7]
    buffer_load_dwordx4 v254, s[44:47], s22 offen offset:2048 sc1 lds
    v_mfma_f32_16x16x32_bf16 v[0:3], a[200:203], v[164:167], v[0:3]
    ds_read_b128 v[188:191], v248 offset:31744
    v_mfma_f32_16x16x32_bf16 v[4:7], a[204:207], v[164:167], v[4:7]
    s_waitcnt lgkmcnt(4)
    v_mfma_f32_16x16x32_bf16 v[0:3], a[208:211], v[168:171], v[0:3]
    s_waitcnt vmcnt(7)
    s_barrier
    ds_read_b128 v[128:131], v248 offset:32768
    v_mfma_f32_16x16x32_bf16 v[4:7], a[212:215], v[168:171], v[4:7]
    buffer_load_dwordx4 v254, s[44:47], s22 offen offset:3072 sc1 lds
    v_mfma_f32_16x16x32_bf16 v[0:3], a[216:219], v[172:175], v[0:3]
    ds_read_b128 v[132:135], v248 offset:33792
    v_mfma_f32_16x16x32_bf16 v[4:7], a[220:223], v[172:175], v[4:7]
    s_waitcnt lgkmcnt(4)
    v_mfma_f32_16x16x32_bf16 v[0:3], a[224:227], v[176:179], v[0:3]
    ds_read_b128 v[136:139], v248 offset:34816
    v_mfma_f32_16x16x32_bf16 v[4:7], a[228:231], v[176:179], v[4:7]
    v_mfma_f32_16x16x32_bf16 v[0:3], a[232:235], v[180:183], v[0:3]
    ds_read_b128 v[140:143], v248 offset:35840
    v_mfma_f32_16x16x32_bf16 v[4:7], a[236:239], v[180:183], v[4:7]
    s_waitcnt lgkmcnt(4)
    v_mfma_f32_16x16x32_bf16 v[0:3], a[240:243], v[184:187], v[0:3]
    ds_read_b128 v[144:147], v248 offset:36864
    v_mfma_f32_16x16x32_bf16 v[4:7], a[244:247], v[184:187], v[4:7]
    v_mfma_f32_16x16x32_bf16 v[0:3], a[248:251], v[188:191], v[0:3]
    ds_read_b128 v[148:151], v248 offset:37888
    v_mfma_f32_16x16x32_bf16 v[4:7], a[252:255], v[188:191], v[4:7]
    s_waitcnt lgkmcnt(4)
    v_mfma_f32_16x16x32_bf16 v[8:11], a[0:3], v[128:131], 0
    ds_read_b128 v[152:155], v248 offset:38912
    v_mfma_f32_16x16x32_bf16 v[12:15], a[4:7], v[128:131], 0
    v_mfma_f32_16x16x32_bf16 v[8:11], a[8:11], v[132:135], v[8:11]
    ds_read_b128 v[156:159], v248 offset:39936
    v_mfma_f32_16x16x32_bf16 v[12:15], a[12:15], v[132:135], v[12:15]
    s_waitcnt lgkmcnt(4)
    v_and_or_b32 v0, v0, s19, v56
    v_and_or_b32 v1, v1, s19, v57
    v_mfma_f32_16x16x32_bf16 v[8:11], a[16:19], v[136:139], v[8:11]
    ds_read_b128 v[160:163], v248 offset:40960
    v_and_or_b32 v2, v2, s19, v58
    v_mfma_f32_16x16x32_bf16 v[12:15], a[20:23], v[136:139], v[12:15]
    v_and_or_b32 v3, v3, s19, v59
    v_and_or_b32 v4, v4, s19, v56
    v_mfma_f32_16x16x32_bf16 v[8:11], a[24:27], v[140:143], v[8:11]
    ds_read_b128 v[164:167], v248 offset:41984
    v_and_or_b32 v5, v5, s19, v57
    v_mfma_f32_16x16x32_bf16 v[12:15], a[28:31], v[140:143], v[12:15]
    s_waitcnt lgkmcnt(4)
    buffer_store_dwordx4 v[0:3], v248, s[44:47], s48 offen offset:0 sc1
    v_mfma_f32_16x16x32_bf16 v[8:11], a[32:35], v[144:147], v[8:11]
    ds_read_b128 v[168:171], v248 offset:43008
    v_and_or_b32 v6, v6, s19, v58
    v_mfma_f32_16x16x32_bf16 v[12:15], a[36:39], v[144:147], v[12:15]
    v_and_or_b32 v7, v7, s19, v59
    v_mfma_f32_16x16x32_bf16 v[8:11], a[40:43], v[148:151], v[8:11]
    ds_read_b128 v[172:175], v248 offset:44032
    v_mfma_f32_16x16x32_bf16 v[12:15], a[44:47], v[148:151], v[12:15]
    s_waitcnt lgkmcnt(4)
    buffer_store_dwordx4 v[4:7], v248, s[44:47], s48 offen offset:1024 sc1
    v_mfma_f32_16x16x32_bf16 v[8:11], a[48:51], v[152:155], v[8:11]
    ds_read_b128 v[176:179], v248 offset:45056
    v_mfma_f32_16x16x32_bf16 v[12:15], a[52:55], v[152:155], v[12:15]
    v_mfma_f32_16x16x32_bf16 v[8:11], a[56:59], v[156:159], v[8:11]
    ds_read_b128 v[180:183], v248 offset:46080
    v_mfma_f32_16x16x32_bf16 v[12:15], a[60:63], v[156:159], v[12:15]
    s_waitcnt lgkmcnt(4)
    v_mfma_f32_16x16x32_bf16 v[8:11], a[64:67], v[160:163], v[8:11]
    s_add_u32 m0, s4, 98304
    ds_read_b128 v[184:187], v248 offset:47104
    v_mfma_f32_16x16x32_bf16 v[12:15], a[68:71], v[160:163], v[12:15]
    buffer_load_dwordx4 v248, s[44:47], s23 offen offset:0 sc1 lds
    v_mfma_f32_16x16x32_bf16 v[8:11], a[72:75], v[164:167], v[8:11]
    ds_read_b128 v[188:191], v248 offset:48128
    v_mfma_f32_16x16x32_bf16 v[12:15], a[76:79], v[164:167], v[12:15]
    s_waitcnt lgkmcnt(4)
    v_mfma_f32_16x16x32_bf16 v[8:11], a[80:83], v[168:171], v[8:11]
    ds_read_b128 v[128:131], v248 offset:49152
    v_mfma_f32_16x16x32_bf16 v[12:15], a[84:87], v[168:171], v[12:15]
    buffer_load_dwordx4 v248, s[44:47], s23 offen offset:1024 sc1 lds
    v_mfma_f32_16x16x32_bf16 v[8:11], a[88:91], v[172:175], v[8:11]
    ds_read_b128 v[132:135], v248 offset:50176
    v_mfma_f32_16x16x32_bf16 v[12:15], a[92:95], v[172:175], v[12:15]
    s_waitcnt lgkmcnt(4)
    v_mfma_f32_16x16x32_bf16 v[8:11], a[96:99], v[176:179], v[8:11]
    ds_read_b128 v[136:139], v248 offset:51200
    v_mfma_f32_16x16x32_bf16 v[12:15], a[100:103], v[176:179], v[12:15]
    buffer_load_dwordx4 v248, s[44:47], s23 offen offset:2048 sc1 lds
    v_mfma_f32_16x16x32_bf16 v[8:11], a[104:107], v[180:183], v[8:11]
    ds_read_b128 v[140:143], v248 offset:52224
    v_mfma_f32_16x16x32_bf16 v[12:15], a[108:111], v[180:183], v[12:15]
    s_waitcnt lgkmcnt(4)
    v_mfma_f32_16x16x32_bf16 v[8:11], a[112:115], v[184:187], v[8:11]
    ds_read_b128 v[144:147], v248 offset:53248
    v_mfma_f32_16x16x32_bf16 v[12:15], a[116:119], v[184:187], v[12:15]
    buffer_load_dwordx4 v248, s[44:47], s23 offen offset:3072 sc1 lds
    v_mfma_f32_16x16x32_bf16 v[8:11], a[120:123], v[188:191], v[8:11]
    ds_read_b128 v[148:151], v248 offset:54272
    v_mfma_f32_16x16x32_bf16 v[12:15], a[124:127], v[188:191], v[12:15]
    s_waitcnt lgkmcnt(4)
    v_mfma_f32_16x16x32_bf16 v[8:11], a[128:131], v[128:131], v[8:11]
    s_add_u32 m0, s5, 98304
    ds_read_b128 v[152:155], v248 offset:55296
    v_mfma_f32_16x16x32_bf16 v[12:15], a[132:135], v[128:131], v[12:15]
    buffer_load_dwordx4 v254, s[44:47], s23 offen offset:0 sc1 lds
    v_mfma_f32_16x16x32_bf16 v[8:11], a[136:139], v[132:135], v[8:11]
    ds_read_b128 v[156:159], v248 offset:56320
    v_mfma_f32_16x16x32_bf16 v[12:15], a[140:143], v[132:135], v[12:15]
    s_waitcnt lgkmcnt(4)
    v_mfma_f32_16x16x32_bf16 v[8:11], a[144:147], v[136:139], v[8:11]
    ds_read_b128 v[160:163], v248 offset:57344
    v_mfma_f32_16x16x32_bf16 v[12:15], a[148:151], v[136:139], v[12:15]
    buffer_load_dwordx4 v254, s[44:47], s23 offen offset:1024 sc1 lds
    v_mfma_f32_16x16x32_bf16 v[8:11], a[152:155], v[140:143], v[8:11]
    ds_read_b128 v[164:167], v248 offset:58368
    v_mfma_f32_16x16x32_bf16 v[12:15], a[156:159], v[140:143], v[12:15]
    s_waitcnt lgkmcnt(4)
    v_mfma_f32_16x16x32_bf16 v[8:11], a[160:163], v[144:147], v[8:11]
    ds_read_b128 v[168:171], v248 offset:59392
    v_mfma_f32_16x16x32_bf16 v[12:15], a[164:167], v[144:147], v[12:15]
    buffer_load_dwordx4 v254, s[44:47], s23 offen offset:2048 sc1 lds
    v_mfma_f32_16x16x32_bf16 v[8:11], a[168:171], v[148:151], v[8:11]
    ds_read_b128 v[172:175], v248 offset:60416
    v_mfma_f32_16x16x32_bf16 v[12:15], a[172:175], v[148:151], v[12:15]
    s_waitcnt lgkmcnt(4)
    v_mfma_f32_16x16x32_bf16 v[8:11], a[176:179], v[152:155], v[8:11]
    ds_read_b128 v[176:179], v248 offset:61440
    v_mfma_f32_16x16x32_bf16 v[12:15], a[180:183], v[152:155], v[12:15]
    buffer_load_dwordx4 v254, s[44:47], s23 offen offset:3072 sc1 lds
    v_mfma_f32_16x16x32_bf16 v[8:11], a[184:187], v[156:159], v[8:11]
    ds_read_b128 v[180:183], v248 offset:62464
    v_mfma_f32_16x16x32_bf16 v[12:15], a[188:191], v[156:159], v[12:15]
    s_waitcnt lgkmcnt(4)
    v_mfma_f32_16x16x32_bf16 v[8:11], a[192:195], v[160:163], v[8:11]
    ds_read_b128 v[184:187], v248 offset:63488
    v_mfma_f32_16x16x32_bf16 v[12:15], a[196:199], v[160:163], v[12:15]
    v_mfma_f32_16x16x32_bf16 v[8:11], a[200:203], v[164:167], v[8:11]
    ds_read_b128 v[188:191], v248 offset:64512
    v_mfma_f32_16x16x32_bf16 v[12:15], a[204:207], v[164:167], v[12:15]
    s_waitcnt lgkmcnt(4)
    v_mfma_f32_16x16x32_bf16 v[8:11], a[208:211], v[168:171], v[8:11]
    s_waitcnt vmcnt(10)
    s_barrier
    ds_read_b128 v[128:131], v252 offset:0
    v_mfma_f32_16x16x32_bf16 v[12:15], a[212:215], v[168:171], v[12:15]
    v_mfma_f32_16x16x32_bf16 v[8:11], a[216:219], v[172:175], v[8:11]
    ds_read_b128 v[132:135], v252 offset:1024
    v_mfma_f32_16x16x32_bf16 v[12:15], a[220:223], v[172:175], v[12:15]
    s_waitcnt lgkmcnt(4)
    v_mfma_f32_16x16x32_bf16 v[8:11], a[224:227], v[176:179], v[8:11]
    ds_read_b128 v[136:139], v252 offset:2048
    v_mfma_f32_16x16x32_bf16 v[12:15], a[228:231], v[176:179], v[12:15]
    v_mfma_f32_16x16x32_bf16 v[8:11], a[232:235], v[180:183], v[8:11]
    ds_read_b128 v[140:143], v252 offset:3072
    v_mfma_f32_16x16x32_bf16 v[12:15], a[236:239], v[180:183], v[12:15]
    s_waitcnt lgkmcnt(4)
    v_mfma_f32_16x16x32_bf16 v[8:11], a[240:243], v[184:187], v[8:11]
    ds_read_b128 v[144:147], v252 offset:4096
    v_mfma_f32_16x16x32_bf16 v[12:15], a[244:247], v[184:187], v[12:15]
    v_mfma_f32_16x16x32_bf16 v[8:11], a[248:251], v[188:191], v[8:11]
    ds_read_b128 v[148:151], v252 offset:5120
    v_mfma_f32_16x16x32_bf16 v[12:15], a[252:255], v[188:191], v[12:15]
    s_waitcnt lgkmcnt(4)
    v_mfma_f32_16x16x32_bf16 v[16:19], a[0:3], v[128:131], 0
    ds_read_b128 v[152:155], v252 offset:6144
    v_mfma_f32_16x16x32_bf16 v[20:23], a[4:7], v[128:131], 0
    v_mfma_f32_16x16x32_bf16 v[16:19], a[8:11], v[132:135], v[16:19]
    ds_read_b128 v[156:159], v252 offset:7168
    v_mfma_f32_16x16x32_bf16 v[20:23], a[12:15], v[132:135], v[20:23]
    s_waitcnt lgkmcnt(4)
    v_and_or_b32 v8, v8, s19, v56
    v_and_or_b32 v9, v9, s19, v57
    v_mfma_f32_16x16x32_bf16 v[16:19], a[16:19], v[136:139], v[16:19]
    ds_read_b128 v[160:163], v252 offset:8192
    v_and_or_b32 v10, v10, s19, v58
    v_mfma_f32_16x16x32_bf16 v[20:23], a[20:23], v[136:139], v[20:23]
    v_and_or_b32 v11, v11, s19, v59
    v_and_or_b32 v12, v12, s19, v56
    v_mfma_f32_16x16x32_bf16 v[16:19], a[24:27], v[140:143], v[16:19]
    ds_read_b128 v[164:167], v252 offset:9216
    v_and_or_b32 v13, v13, s19, v57
    v_mfma_f32_16x16x32_bf16 v[20:23], a[28:31], v[140:143], v[20:23]
    s_waitcnt lgkmcnt(4)
    buffer_store_dwordx4 v[8:11], v248, s[44:47], s49 offen offset:0 sc1
    v_mfma_f32_16x16x32_bf16 v[16:19], a[32:35], v[144:147], v[16:19]
    ds_read_b128 v[168:171], v252 offset:10240
    v_and_or_b32 v14, v14, s19, v58
    v_mfma_f32_16x16x32_bf16 v[20:23], a[36:39], v[144:147], v[20:23]
    v_and_or_b32 v15, v15, s19, v59
    v_mfma_f32_16x16x32_bf16 v[16:19], a[40:43], v[148:151], v[16:19]
    ds_read_b128 v[172:175], v252 offset:11264
    v_mfma_f32_16x16x32_bf16 v[20:23], a[44:47], v[148:151], v[20:23]
    s_waitcnt lgkmcnt(4)
    buffer_store_dwordx4 v[12:15], v248, s[44:47], s49 offen offset:1024 sc1
    v_mfma_f32_16x16x32_bf16 v[16:19], a[48:51], v[152:155], v[16:19]
    ds_read_b128 v[176:179], v252 offset:12288
    v_mfma_f32_16x16x32_bf16 v[20:23], a[52:55], v[152:155], v[20:23]
    v_mfma_f32_16x16x32_bf16 v[16:19], a[56:59], v[156:159], v[16:19]
    ds_read_b128 v[180:183], v252 offset:13312
    v_mfma_f32_16x16x32_bf16 v[20:23], a[60:63], v[156:159], v[20:23]
    s_waitcnt lgkmcnt(4)
    v_mfma_f32_16x16x32_bf16 v[16:19], a[64:67], v[160:163], v[16:19]
    ds_read_b128 v[184:187], v252 offset:14336
    v_mfma_f32_16x16x32_bf16 v[20:23], a[68:71], v[160:163], v[20:23]
    v_mfma_f32_16x16x32_bf16 v[16:19], a[72:75], v[164:167], v[16:19]
    ds_read_b128 v[188:191], v252 offset:15360
    v_mfma_f32_16x16x32_bf16 v[20:23], a[76:79], v[164:167], v[20:23]
    s_waitcnt lgkmcnt(4)
    v_mfma_f32_16x16x32_bf16 v[16:19], a[80:83], v[168:171], v[16:19]
    ds_read_b128 v[128:131], v252 offset:16384
    v_mfma_f32_16x16x32_bf16 v[20:23], a[84:87], v[168:171], v[20:23]
    v_mfma_f32_16x16x32_bf16 v[16:19], a[88:91], v[172:175], v[16:19]
    ds_read_b128 v[132:135], v252 offset:17408
    v_mfma_f32_16x16x32_bf16 v[20:23], a[92:95], v[172:175], v[20:23]
    s_waitcnt lgkmcnt(4)
    v_mfma_f32_16x16x32_bf16 v[16:19], a[96:99], v[176:179], v[16:19]
    ds_read_b128 v[136:139], v252 offset:18432
    v_mfma_f32_16x16x32_bf16 v[20:23], a[100:103], v[176:179], v[20:23]
    v_mfma_f32_16x16x32_bf16 v[16:19], a[104:107], v[180:183], v[16:19]
    ds_read_b128 v[140:143], v252 offset:19456
    v_mfma_f32_16x16x32_bf16 v[20:23], a[108:111], v[180:183], v[20:23]
    s_waitcnt lgkmcnt(4)
    v_mfma_f32_16x16x32_bf16 v[16:19], a[112:115], v[184:187], v[16:19]
    ds_read_b128 v[144:147], v252 offset:20480
    v_mfma_f32_16x16x32_bf16 v[20:23], a[116:119], v[184:187], v[20:23]
    v_mfma_f32_16x16x32_bf16 v[16:19], a[120:123], v[188:191], v[16:19]
    ds_read_b128 v[148:151], v252 offset:21504
    v_mfma_f32_16x16x32_bf16 v[20:23], a[124:127], v[188:191], v[20:23]
    s_waitcnt lgkmcnt(4)
    v_mfma_f32_16x16x32_bf16 v[16:19], a[128:131], v[128:131], v[16:19]
    ds_read_b128 v[152:155], v252 offset:22528
    v_mfma_f32_16x16x32_bf16 v[20:23], a[132:135], v[128:131], v[20:23]
    buffer_load_dwordx4 v[48:51], v248, s[44:47], s18 offen offset:0 sc1
    v_mfma_f32_16x16x32_bf16 v[16:19], a[136:139], v[132:135], v[16:19]
    ds_read_b128 v[156:159], v252 offset:23552
    v_mfma_f32_16x16x32_bf16 v[20:23], a[140:143], v[132:135], v[20:23]
    s_waitcnt lgkmcnt(4)
    buffer_load_dwordx4 v[52:55], v248, s[44:47], s18 offen offset:1024 sc1
    v_mfma_f32_16x16x32_bf16 v[16:19], a[144:147], v[136:139], v[16:19]
    ds_read_b128 v[160:163], v252 offset:24576
    v_mfma_f32_16x16x32_bf16 v[20:23], a[148:151], v[136:139], v[20:23]
    v_mfma_f32_16x16x32_bf16 v[16:19], a[152:155], v[140:143], v[16:19]
    ds_read_b128 v[164:167], v252 offset:25600
    v_mfma_f32_16x16x32_bf16 v[20:23], a[156:159], v[140:143], v[20:23]
    s_waitcnt lgkmcnt(4)
    v_mfma_f32_16x16x32_bf16 v[16:19], a[160:163], v[144:147], v[16:19]
    ds_read_b128 v[168:171], v252 offset:26624
    v_mfma_f32_16x16x32_bf16 v[20:23], a[164:167], v[144:147], v[20:23]
    v_mfma_f32_16x16x32_bf16 v[16:19], a[168:171], v[148:151], v[16:19]
    ds_read_b128 v[172:175], v252 offset:27648
    v_mfma_f32_16x16x32_bf16 v[20:23], a[172:175], v[148:151], v[20:23]
    s_waitcnt lgkmcnt(4)
    v_mfma_f32_16x16x32_bf16 v[16:19], a[176:179], v[152:155], v[16:19]
    ds_read_b128 v[176:179], v252 offset:28672
    v_mfma_f32_16x16x32_bf16 v[20:23], a[180:183], v[152:155], v[20:23]
    v_mfma_f32_16x16x32_bf16 v[16:19], a[184:187], v[156:159], v[16:19]
    ds_read_b128 v[180:183], v252 offset:29696
    v_mfma_f32_16x16x32_bf16 v[20:23], a[188:191], v[156:159], v[20:23]
    s_waitcnt lgkmcnt(4)
    v_mfma_f32_16x16x32_bf16 v[16:19], a[192:195], v[160:163], v[16:19]
    ds_read_b128 v[184:187], v252 offset:30720
    v_mfma_f32_16x16x32_bf16 v[20:23], a[196:199], v[160:163], v[20:23]
    v_mfma_f32_16x16x32_bf16 v[16:19], a[200:203], v[164:167], v[16:19]
    ds_read_b128 v[188:191], v252 offset:31744
    v_mfma_f32_16x16x32_bf16 v[20:23], a[204:207], v[164:167], v[20:23]
    s_waitcnt lgkmcnt(4)
    v_mfma_f32_16x16x32_bf16 v[16:19], a[208:211], v[168:171], v[16:19]
    s_waitcnt vmcnt(4)
    s_barrier
    ds_read_b128 v[128:131], v252 offset:32768
    v_mfma_f32_16x16x32_bf16 v[20:23], a[212:215], v[168:171], v[20:23]
    v_mfma_f32_16x16x32_bf16 v[16:19], a[216:219], v[172:175], v[16:19]
    ds_read_b128 v[132:135], v252 offset:33792
    v_mfma_f32_16x16x32_bf16 v[20:23], a[220:223], v[172:175], v[20:23]
    s_waitcnt lgkmcnt(4)
    v_mfma_f32_16x16x32_bf16 v[16:19], a[224:227], v[176:179], v[16:19]
    ds_read_b128 v[136:139], v252 offset:34816
    v_mfma_f32_16x16x32_bf16 v[20:23], a[228:231], v[176:179], v[20:23]
    v_mfma_f32_16x16x32_bf16 v[16:19], a[232:235], v[180:183], v[16:19]
    ds_read_b128 v[140:143], v252 offset:35840
    v_mfma_f32_16x16x32_bf16 v[20:23], a[236:239], v[180:183], v[20:23]
    s_waitcnt lgkmcnt(4)
    v_mfma_f32_16x16x32_bf16 v[16:19], a[240:243], v[184:187], v[16:19]
    ds_read_b128 v[144:147], v252 offset:36864
    v_mfma_f32_16x16x32_bf16 v[20:23], a[244:247], v[184:187], v[20:23]
    v_mfma_f32_16x16x32_bf16 v[16:19], a[248:251], v[188:191], v[16:19]
    ds_read_b128 v[148:151], v252 offset:37888
    v_mfma_f32_16x16x32_bf16 v[20:23], a[252:255], v[188:191], v[20:23]
    s_waitcnt lgkmcnt(4)
    v_mfma_f32_16x16x32_bf16 v[24:27], a[0:3], v[128:131], 0
    ds_read_b128 v[152:155], v252 offset:38912
    v_mfma_f32_16x16x32_bf16 v[28:31], a[4:7], v[128:131], 0
    v_mfma_f32_16x16x32_bf16 v[24:27], a[8:11], v[132:135], v[24:27]
    ds_read_b128 v[156:159], v252 offset:39936
    v_mfma_f32_16x16x32_bf16 v[28:31], a[12:15], v[132:135], v[28:31]
    s_waitcnt lgkmcnt(4)
    v_and_or_b32 v16, v16, s19, v56
    v_and_or_b32 v17, v17, s19, v57
    v_and_or_b32 v18, v18, s19, v58
    v_and_or_b32 v19, v19, s19, v59
    buffer_store_dwordx4 v[16:19], v248, s[44:47], s50 offen offset:0 sc1
    v_mfma_f32_16x16x32_bf16 v[24:27], a[16:19], v[136:139], v[24:27]
    ds_read_b128 v[160:163], v252 offset:40960
    v_and_or_b32 v20, v20, s19, v56
    v_mfma_f32_16x16x32_bf16 v[28:31], a[20:23], v[136:139], v[28:31]
    v_and_or_b32 v21, v21, s19, v57
    v_and_or_b32 v22, v22, s19, v58
    v_and_or_b32 v23, v23, s19, v59
    buffer_store_dwordx4 v[20:23], v248, s[44:47], s50 offen offset:1024 sc1
    v_mfma_f32_16x16x32_bf16 v[24:27], a[24:27], v[140:143], v[24:27]
    ds_read_b128 v[164:167], v252 offset:41984
    v_mfma_f32_16x16x32_bf16 v[28:31], a[28:31], v[140:143], v[28:31]
    s_waitcnt lgkmcnt(4)
    v_mfma_f32_16x16x32_bf16 v[24:27], a[32:35], v[144:147], v[24:27]
    ds_read_b128 v[168:171], v252 offset:43008
    v_mfma_f32_16x16x32_bf16 v[28:31], a[36:39], v[144:147], v[28:31]
    v_mfma_f32_16x16x32_bf16 v[24:27], a[40:43], v[148:151], v[24:27]
    ds_read_b128 v[172:175], v252 offset:44032
    v_mfma_f32_16x16x32_bf16 v[28:31], a[44:47], v[148:151], v[28:31]
    s_waitcnt lgkmcnt(4)
    v_mfma_f32_16x16x32_bf16 v[24:27], a[48:51], v[152:155], v[24:27]
    ds_read_b128 v[176:179], v252 offset:45056
    v_mfma_f32_16x16x32_bf16 v[28:31], a[52:55], v[152:155], v[28:31]
    buffer_load_dwordx4 v[40:43], v248, s[44:47], s16 offen offset:0 sc1
    v_mfma_f32_16x16x32_bf16 v[24:27], a[56:59], v[156:159], v[24:27]
    ds_read_b128 v[180:183], v252 offset:46080
    v_mfma_f32_16x16x32_bf16 v[28:31], a[60:63], v[156:159], v[28:31]
    s_waitcnt lgkmcnt(4)
    buffer_load_dwordx4 v[44:47], v248, s[44:47], s16 offen offset:1024 sc1
    v_mfma_f32_16x16x32_bf16 v[24:27], a[64:67], v[160:163], v[24:27]
    ds_read_b128 v[184:187], v252 offset:47104
    v_mfma_f32_16x16x32_bf16 v[28:31], a[68:71], v[160:163], v[28:31]
    v_mfma_f32_16x16x32_bf16 v[24:27], a[72:75], v[164:167], v[24:27]
    ds_read_b128 v[188:191], v252 offset:48128
    v_mfma_f32_16x16x32_bf16 v[28:31], a[76:79], v[164:167], v[28:31]
    s_waitcnt lgkmcnt(4)
    v_mfma_f32_16x16x32_bf16 v[24:27], a[80:83], v[168:171], v[24:27]
    ds_read_b128 v[128:131], v252 offset:49152
    v_mfma_f32_16x16x32_bf16 v[28:31], a[84:87], v[168:171], v[28:31]
    v_mfma_f32_16x16x32_bf16 v[24:27], a[88:91], v[172:175], v[24:27]
    ds_read_b128 v[132:135], v252 offset:50176
    v_mfma_f32_16x16x32_bf16 v[28:31], a[92:95], v[172:175], v[28:31]
    s_waitcnt lgkmcnt(4)
    v_mfma_f32_16x16x32_bf16 v[24:27], a[96:99], v[176:179], v[24:27]
    ds_read_b128 v[136:139], v252 offset:51200
    v_mfma_f32_16x16x32_bf16 v[28:31], a[100:103], v[176:179], v[28:31]
    v_mfma_f32_16x16x32_bf16 v[24:27], a[104:107], v[180:183], v[24:27]
    ds_read_b128 v[140:143], v252 offset:52224
    v_mfma_f32_16x16x32_bf16 v[28:31], a[108:111], v[180:183], v[28:31]
    s_waitcnt lgkmcnt(4)
    v_mfma_f32_16x16x32_bf16 v[24:27], a[112:115], v[184:187], v[24:27]
    ds_read_b128 v[144:147], v252 offset:53248
    v_mfma_f32_16x16x32_bf16 v[28:31], a[116:119], v[184:187], v[28:31]
    v_mfma_f32_16x16x32_bf16 v[24:27], a[120:123], v[188:191], v[24:27]
    ds_read_b128 v[148:151], v252 offset:54272
    v_mfma_f32_16x16x32_bf16 v[28:31], a[124:127], v[188:191], v[28:31]
    s_waitcnt lgkmcnt(4)
    v_mfma_f32_16x16x32_bf16 v[24:27], a[128:131], v[128:131], v[24:27]
    ds_read_b128 v[152:155], v252 offset:55296
    v_mfma_f32_16x16x32_bf16 v[28:31], a[132:135], v[128:131], v[28:31]
    v_mfma_f32_16x16x32_bf16 v[24:27], a[136:139], v[132:135], v[24:27]
    ds_read_b128 v[156:159], v252 offset:56320
    v_mfma_f32_16x16x32_bf16 v[28:31], a[140:143], v[132:135], v[28:31]
    s_waitcnt lgkmcnt(4)
    v_mfma_f32_16x16x32_bf16 v[24:27], a[144:147], v[136:139], v[24:27]
    ds_read_b128 v[160:163], v252 offset:57344
    v_mfma_f32_16x16x32_bf16 v[28:31], a[148:151], v[136:139], v[28:31]
    v_mfma_f32_16x16x32_bf16 v[24:27], a[152:155], v[140:143], v[24:27]
    ds_read_b128 v[164:167], v252 offset:58368
    v_mfma_f32_16x16x32_bf16 v[28:31], a[156:159], v[140:143], v[28:31]
    s_waitcnt lgkmcnt(4)
    v_mfma_f32_16x16x32_bf16 v[24:27], a[160:163], v[144:147], v[24:27]
    ds_read_b128 v[168:171], v252 offset:59392
    v_mfma_f32_16x16x32_bf16 v[28:31], a[164:167], v[144:147], v[28:31]
    buffer_load_dwordx4 v[32:35], v248, s[44:47], s15 offen offset:0 sc1
    v_mfma_f32_16x16x32_bf16 v[24:27], a[168:171], v[148:151], v[24:27]
    ds_read_b128 v[172:175], v252 offset:60416
    v_mfma_f32_16x16x32_bf16 v[28:31], a[172:175], v[148:151], v[28:31]
    s_waitcnt lgkmcnt(4)
    buffer_load_dwordx4 v[36:39], v248, s[44:47], s15 offen offset:1024 sc1
    v_mfma_f32_16x16x32_bf16 v[24:27], a[176:179], v[152:155], v[24:27]
    ds_read_b128 v[176:179], v252 offset:61440
    v_mfma_f32_16x16x32_bf16 v[28:31], a[180:183], v[152:155], v[28:31]
    v_mfma_f32_16x16x32_bf16 v[24:27], a[184:187], v[156:159], v[24:27]
    ds_read_b128 v[180:183], v252 offset:62464
    v_mfma_f32_16x16x32_bf16 v[28:31], a[188:191], v[156:159], v[28:31]
    s_waitcnt lgkmcnt(4)
    v_mfma_f32_16x16x32_bf16 v[24:27], a[192:195], v[160:163], v[24:27]
    ds_read_b128 v[184:187], v252 offset:63488
    v_mfma_f32_16x16x32_bf16 v[28:31], a[196:199], v[160:163], v[28:31]
    v_mfma_f32_16x16x32_bf16 v[24:27], a[200:203], v[164:167], v[24:27]
    ds_read_b128 v[188:191], v252 offset:64512
    v_mfma_f32_16x16x32_bf16 v[28:31], a[204:207], v[164:167], v[28:31]
    s_waitcnt lgkmcnt(4)
    v_mfma_f32_16x16x32_bf16 v[24:27], a[208:211], v[168:171], v[24:27]
    v_mfma_f32_16x16x32_bf16 v[28:31], a[212:215], v[168:171], v[28:31]
    v_mfma_f32_16x16x32_bf16 v[24:27], a[216:219], v[172:175], v[24:27]
    v_mfma_f32_16x16x32_bf16 v[28:31], a[220:223], v[172:175], v[28:31]
    s_waitcnt lgkmcnt(2)
    v_mfma_f32_16x16x32_bf16 v[24:27], a[224:227], v[176:179], v[24:27]
    v_mfma_f32_16x16x32_bf16 v[28:31], a[228:231], v[176:179], v[28:31]
    v_mfma_f32_16x16x32_bf16 v[24:27], a[232:235], v[180:183], v[24:27]
    v_mfma_f32_16x16x32_bf16 v[28:31], a[236:239], v[180:183], v[28:31]
    s_waitcnt lgkmcnt(0)
    v_mfma_f32_16x16x32_bf16 v[24:27], a[240:243], v[184:187], v[24:27]
    v_mfma_f32_16x16x32_bf16 v[28:31], a[244:247], v[184:187], v[28:31]
    v_mfma_f32_16x16x32_bf16 v[24:27], a[248:251], v[188:191], v[24:27]
    v_mfma_f32_16x16x32_bf16 v[28:31], a[252:255], v[188:191], v[28:31]
    s_mov_b32 s73, 0
    s_mov_b32 s77, 0
    s_waitcnt vmcnt(2)
    v_xor_b32 v48, v48, v56
    v_xor_b32 v49, v49, v57
    v_xor_b32 v50, v50, v58
    v_xor_b32 v51, v51, v59
    v_xor_b32 v52, v52, v56
    v_xor_b32 v53, v53, v57
    v_xor_b32 v54, v54, v58
    v_xor_b32 v55, v55, v59
    v_or3_b32 v250, v48, v49, v50
    v_or3_b32 v250, v250, v51, v52
    v_or3_b32 v250, v250, v53, v54
    v_bitop3_b32 v250, v250, v55, s19 bitop3:0x54
    v_cmp_ne_u32 vcc, 0, v250
    s_cbranch_vccz L_xok2a
    buffer_load_dwordx4 v[48:51], v248, s[44:47], s18 offen offset:0 sc1
    buffer_load_dwordx4 v[52:55], v248, s[44:47], s18 offen offset:1024 sc1
    s_branch L_xnext2a
L_xok2a:
    s_bitset1_b32 s77, 2
L_xnext2a:
    v_xor_b32 v40, v40, v56
    v_xor_b32 v41, v41, v57
    v_xor_b32 v42, v42, v58
    v_xor_b32 v43, v43, v59
    v_xor_b32 v44, v44, v56
    v_xor_b32 v45, v45, v57
    v_xor_b32 v46, v46, v58
    v_xor_b32 v47, v47, v59
    v_or3_b32 v250, v40, v41, v42
    v_or3_b32 v250, v250, v43, v44
    v_or3_b32 v250, v250, v45, v46
    v_bitop3_b32 v250, v250, v47, s19 bitop3:0x54
    v_cmp_ne_u32 vcc, 0, v250
    s_cbranch_vccz L_xok1a
    buffer_load_dwordx4 v[40:43], v248, s[44:47], s16 offen offset:0 sc1
    buffer_load_dwordx4 v[44:47], v248, s[44:47], s16 offen offset:1024 sc1
    s_branch L_xnext1a
L_xok1a:
    s_bitset1_b32 s77, 1
L_xnext1a:
L_poll_x:
    s_waitcnt vmcnt(0)
    s_bitcmp1_b32 s77, 0
    s_cbranch_scc1 L_xnext0b
    v_xor_b32 v32, v32, v56
    v_xor_b32 v33, v33, v57
    v_xor_b32 v34, v34, v58
    v_xor_b32 v35, v35, v59
    v_xor_b32 v36, v36, v56
    v_xor_b32 v37, v37, v57
    v_xor_b32 v38, v38, v58
    v_xor_b32 v39, v39, v59
    v_or3_b32 v250, v32, v33, v34
    v_or3_b32 v250, v250, v35, v36
    v_or3_b32 v250, v250, v37, v38
    v_bitop3_b32 v250, v250, v39, s19 bitop3:0x54
    v_cmp_ne_u32 vcc, 0, v250
    s_cbranch_vccz L_xok0b
    buffer_load_dwordx4 v[32:35], v248, s[44:47], s15 offen offset:0 sc1
    buffer_load_dwordx4 v[36:39], v248, s[44:47], s15 offen offset:1024 sc1
    s_branch L_xnext0b
L_xok0b:
    s_bitset1_b32 s77, 0
L_xnext0b:
    s_bitcmp1_b32 s77, 1
    s_cbranch_scc1 L_xnext1b
    v_xor_b32 v40, v40, v56
    v_xor_b32 v41, v41, v57
    v_xor_b32 v42, v42, v58
    v_xor_b32 v43, v43, v59
    v_xor_b32 v44, v44, v56
    v_xor_b32 v45, v45, v57
    v_xor_b32 v46, v46, v58
    v_xor_b32 v47, v47, v59
    v_or3_b32 v250, v40, v41, v42
    v_or3_b32 v250, v250, v43, v44
    v_or3_b32 v250, v250, v45, v46
    v_bitop3_b32 v250, v250, v47, s19 bitop3:0x54
    v_cmp_ne_u32 vcc, 0, v250
    s_cbranch_vccz L_xok1b
    buffer_load_dwordx4 v[40:43], v248, s[44:47], s16 offen offset:0 sc1
    buffer_load_dwordx4 v[44:47], v248, s[44:47], s16 offen offset:1024 sc1
    s_branch L_xnext1b
L_xok1b:
    s_bitset1_b32 s77, 1
L_xnext1b:
    s_bitcmp1_b32 s77, 2
    s_cbranch_scc1 L_xnext2b
    v_xor_b32 v48, v48, v56
    v_xor_b32 v49, v49, v57
    v_xor_b32 v50, v50, v58
    v_xor_b32 v51, v51, v59
    v_xor_b32 v52, v52, v56
    v_xor_b32 v53, v53, v57
    v_xor_b32 v54, v54, v58
    v_xor_b32 v55, v55, v59
    v_or3_b32 v250, v48, v49, v50
    v_or3_b32 v250, v250, v51, v52
    v_or3_b32 v250, v250, v53, v54
    v_bitop3_b32 v250, v250, v55, s19 bitop3:0x54
    v_cmp_ne_u32 vcc, 0, v250
    s_cbranch_vccz L_xok2b
    buffer_load_dwordx4 v[48:51], v248, s[44:47], s18 offen offset:0 sc1
    buffer_load_dwordx4 v[52:55], v248, s[44:47], s18 offen offset:1024 sc1
    s_branch L_xnext2b
L_xok2b:
    s_bitset1_b32 s77, 2
L_xnext2b:
    s_cmp_eq_u32 s77, 7
    s_cbranch_scc1 L_polled_x
    s_add_u32 s73, s73, 1
    s_cmp_gt_u32 s73, 200000
    s_cbranch_scc0 L_poll_x
    s_waitcnt vmcnt(0)
L_polled_x:
    v_add_f32 v32, v32, v40
    v_add_f32 v24, v24, v48
    v_add_f32 v33, v33, v41
    v_add_f32 v25, v25, v49
    v_add_f32 v34, v34, v42
    v_add_f32 v26, v26, v50
    v_add_f32 v35, v35, v43
    v_add_f32 v27, v27, v51
    v_add_f32 v36, v36, v44
    v_add_f32 v28, v28, v52
    v_add_f32 v37, v37, v45
    v_add_f32 v29, v29, v53
    v_add_f32 v38, v38, v46
    v_add_f32 v30, v30, v54
    v_add_f32 v39, v39, v47
    v_add_f32 v31, v31, v55
    v_add_f32 v24, v24, v32
    v_add_f32 v25, v25, v33
    v_add_f32 v26, v26, v34
    v_add_f32 v27, v27, v35
    v_add_f32 v28, v28, v36
    v_add_f32 v29, v29, v37
    v_add_f32 v30, v30, v38
    v_add_f32 v31, v31, v39
    v_cvt_pk_bf16_f32 v32, v24, v25
    v_cvt_pk_bf16_f32 v33, v26, v27
    v_cvt_pk_bf16_f32 v34, v28, v29
    v_cvt_pk_bf16_f32 v35, v30, v31
    buffer_store_dwordx4 v[32:35], v110, s[40:43], s7 offen
L_done:
    s_endpgm
L_wo_main:
    s_add_u32 m0, s75, 4096
    s_and_b32 s17, s17, 0x1fffff
    buffer_load_dwordx4 v109, s[36:39], s17 offen lds
    s_add_u32 s17, s17, 32768
    s_add_u32 m0, s75, 5120
    s_and_b32 s17, s17, 0x1fffff
    buffer_load_dwordx4 v109, s[36:39], s17 offen lds
    s_add_u32 s17, s17, 32768
    s_add_u32 m0, s75, 6144
    s_and_b32 s17, s17, 0x1fffff
    buffer_load_dwordx4 v109, s[36:39], s17 offen lds
    s_add_u32 s17, s17, 32768
    s_add_u32 m0, s75, 7168
    s_and_b32 s17, s17, 0x1fffff
    buffer_load_dwordx4 v109, s[36:39], s17 offen lds
    s_add_u32 s17, s17, 32768
    s_add_u32 m0, s75, 8192
    s_and_b32 s17, s17, 0x1fffff
    buffer_load_dwordx4 v109, s[36:39], s17 offen lds
    s_add_u32 s17, s17, 32768
    s_add_u32 m0, s75, 9216
    s_and_b32 s17, s17, 0x1fffff
    buffer_load_dwordx4 v109, s[36:39], s17 offen lds
    s_add_u32 s17, s17, 32768
    s_add_u32 m0, s75, 10240
    s_and_b32 s17, s17, 0x1fffff
    buffer_load_dwordx4 v109, s[36:39], s17 offen lds
    s_add_u32 s17, s17, 32768
    s_add_u32 m0, s75, 11264
    s_and_b32 s17, s17, 0x1fffff
    buffer_load_dwordx4 v109, s[36:39], s17 offen lds
    s_add_u32 s17, s17, 32768
    s_waitcnt vmcnt(11)
    ds_read_b64_tr_b16 a[0:1], v111 offset:0
    ds_read_b64_tr_b16 a[4:5], v111 offset:8
    s_add_u32 m0, s75, 12288
    s_and_b32 s17, s17, 0x1fffff
    buffer_load_dwordx4 v109, s[36:39], s17 offen lds
    s_add_u32 s17, s17, 32768
    s_waitcnt vmcnt(11)
    ds_read_b64_tr_b16 a[2:3], v111 offset:1024
    ds_read_b64_tr_b16 a[6:7], v111 offset:1032
    s_add_u32 m0, s75, 13312
    s_and_b32 s17, s17, 0x1fffff
    buffer_load_dwordx4 v109, s[36:39], s17 offen lds
    s_add_u32 s17, s17, 32768
    s_waitcnt vmcnt(11)
    ds_read_b64_tr_b16 a[8:9], v111 offset:2048
    ds_read_b64_tr_b16 a[12:13], v111 offset:2056
    s_add_u32 m0, s75, 14336
    s_and_b32 s17, s17, 0x1fffff
    buffer_load_dwordx4 v109, s[36:39], s17 offen lds
    s_add_u32 s17, s17, 32768
    s_waitcnt vmcnt(11)
    ds_read_b64_tr_b16 a[10:11], v111 offset:3072
    ds_read_b64_tr_b16 a[14:15], v111 offset:3080
    s_waitcnt lgkmcnt(6)
    s_add_u32 m0, s75, 0
    s_and_b32 s17, s17, 0x1fffff
    buffer_load_dwordx4 v109, s[36:39], s17 offen lds
    s_add_u32 s17, s17, 32768
    s_waitcnt vmcnt(11)
    ds_read_b64_tr_b16 a[16:17], v111 offset:4096
    ds_read_b64_tr_b16 a[20:21], v111 offset:4104
    s_waitcnt lgkmcnt(6)
    s_add_u32 m0, s75, 1024
    s_and_b32 s17, s17, 0x1fffff
    buffer_load_dwordx4 v109, s[36:39], s17 offen lds
    s_add_u32 s17, s17, 32768
    s_waitcnt vmcnt(11)
    ds_read_b64_tr_b16 a[18:19], v111 offset:5120
    ds_read_b64_tr_b16 a[22:23], v111 offset:5128
    s_waitcnt lgkmcnt(6)
    s_add_u32 m0, s75, 2048
    s_and_b32 s17, s17, 0x1fffff
    buffer_load_dwordx4 v109, s[36:39], s17 offen lds
    s_add_u32 s17, s17, 32768
    s_waitcnt vmcnt(11)
    ds_read_b64_tr_b16 a[24:25], v111 offset:6144
    ds_read_b64_tr_b16 a[28:29], v111 offset:6152
    s_waitcnt lgkmcnt(6)
    s_add_u32 m0, s75, 3072
    s_and_b32 s17, s17, 0x1fffff
    buffer_load_dwordx4 v109, s[36:39], s17 offen lds
    s_add_u32 s17, s17, 32768
    s_waitcnt vmcnt(11)
    ds_read_b64_tr_b16 a[26:27], v111 offset:7168
    ds_read_b64_tr_b16 a[30:31], v111 offset:7176
    s_waitcnt lgkmcnt(6)
    s_add_u32 m0, s75, 4096
    s_and_b32 s17, s17, 0x1fffff
    buffer_load_dwordx4 v109, s[36:39], s17 offen lds
    s_add_u32 s17, s17, 32768
    s_waitcnt vmcnt(11)
    ds_read_b64_tr_b16 a[32:33], v111 offset:8192
    ds_read_b64_tr_b16 a[36:37], v111 offset:8200
    s_waitcnt lgkmcnt(6)
    s_add_u32 m0, s75, 5120
    s_and_b32 s17, s17, 0x1fffff
    buffer_load_dwordx4 v109, s[36:39], s17 offen lds
    s_add_u32 s17, s17, 32768
    s_waitcnt vmcnt(11)
    ds_read_b64_tr_b16 a[34:35], v111 offset:9216
    ds_read_b64_tr_b16 a[38:39], v111 offset:9224
    s_waitcnt lgkmcnt(6)
    s_add_u32 m0, s75, 6144
    s_and_b32 s17, s17, 0x1fffff
    buffer_load_dwordx4 v109, s[36:39], s17 offen lds
    s_add_u32 s17, s17, 32768
    s_waitcnt vmcnt(11)
    ds_read_b64_tr_b16 a[40:41], v111 offset:10240
    ds_read_b64_tr_b16 a[44:45], v111 offset:10248
    s_waitcnt lgkmcnt(6)
    s_add_u32 m0, s75, 7168
    s_and_b32 s17, s17, 0x1fffff
    buffer_load_dwordx4 v109, s[36:39], s17 offen lds
    s_add_u32 s17, s17, 32768
    s_waitcnt vmcnt(11)
    ds_read_b64_tr_b16 a[42:43], v111 offset:11264
    ds_read_b64_tr_b16 a[46:47], v111 offset:11272
    s_waitcnt lgkmcnt(6)
    s_add_u32 m0, s75, 8192
    s_and_b32 s17, s17, 0x1fffff
    buffer_load_dwordx4 v109, s[36:39], s17 offen lds
    s_add_u32 s17, s17, 32768
    s_waitcnt vmcnt(11)
    ds_read_b64_tr_b16 a[48:49], v111 offset:12288
    ds_read_b64_tr_b16 a[52:53], v111 offset:12296
    s_waitcnt lgkmcnt(6)
    s_add_u32 m0, s75, 9216
    s_and_b32 s17, s17, 0x1fffff
    buffer_load_dwordx4 v109, s[36:39], s17 offen lds
    s_add_u32 s17, s17, 32768
    s_waitcnt vmcnt(11)
    ds_read_b64_tr_b16 a[50:51], v111 offset:13312
    ds_read_b64_tr_b16 a[54:55], v111 offset:13320
    s_waitcnt lgkmcnt(6)
    s_add_u32 m0, s75, 10240
    s_and_b32 s17, s17, 0x1fffff
    buffer_load_dwordx4 v109, s[36:39], s17 offen lds
    s_add_u32 s17, s17, 32768
    s_waitcnt vmcnt(11)
    ds_read_b64_tr_b16 a[56:57], v111 offset:14336
    ds_read_b64_tr_b16 a[60:61], v111 offset:14344
    s_waitcnt lgkmcnt(6)
    s_add_u32 m0, s75, 11264
    s_and_b32 s17, s17, 0x1fffff
    buffer_load_dwordx4 v109, s[36:39], s17 offen lds
    s_add_u32 s17, s17, 32768
    s_waitcnt vmcnt(11)
    ds_read_b64_tr_b16 a[58:59], v111 offset:0
    ds_read_b64_tr_b16 a[62:63], v111 offset:8
    s_waitcnt lgkmcnt(6)
    s_add_u32 m0, s75, 12288
    s_and_b32 s17, s17, 0x1fffff
    buffer_load_dwordx4 v109, s[36:39], s17 offen lds
    s_add_u32 s17, s17, 32768
    s_waitcnt vmcnt(11)
    ds_read_b64_tr_b16 a[64:65], v111 offset:1024
    ds_read_b64_tr_b16 a[68:69], v111 offset:1032
    s_waitcnt lgkmcnt(6)
    s_add_u32 m0, s75, 13312
    s_and_b32 s17, s17, 0x1fffff
    buffer_load_dwordx4 v109, s[36:39], s17 offen lds
    s_add_u32 s17, s17, 32768
    s_waitcnt vmcnt(11)
    ds_read_b64_tr_b16 a[66:67], v111 offset:2048
    ds_read_b64_tr_b16 a[70:71], v111 offset:2056
    s_waitcnt lgkmcnt(6)
    s_add_u32 m0, s75, 14336
    s_and_b32 s17, s17, 0x1fffff
    buffer_load_dwordx4 v109, s[36:39], s17 offen lds
    s_add_u32 s17, s17, 32768
    s_waitcnt vmcnt(11)
    ds_read_b64_tr_b16 a[72:73], v111 offset:3072
    ds_read_b64_tr_b16 a[76:77], v111 offset:3080
    s_waitcnt lgkmcnt(6)
    s_add_u32 m0, s75, 0
    s_and_b32 s17, s17, 0x1fffff
    buffer_load_dwordx4 v109, s[36:39], s17 offen lds
    s_add_u32 s17, s17, 32768
    s_waitcnt vmcnt(11)
    ds_read_b64_tr_b16 a[74:75], v111 offset:4096
    ds_read_b64_tr_b16 a[78:79], v111 offset:4104
    s_waitcnt lgkmcnt(6)
    s_add_u32 m0, s75, 1024
    s_and_b32 s17, s17, 0x1fffff
    buffer_load_dwordx4 v109, s[36:39], s17 offen lds
    s_add_u32 s17, s17, 32768
    s_waitcnt vmcnt(11)
    ds_read_b64_tr_b16 a[80:81], v111 offset:5120
    ds_read_b64_tr_b16 a[84:85], v111 offset:5128
    s_waitcnt lgkmcnt(6)
    s_add_u32 m0, s75, 2048
    s_and_b32 s17, s17, 0x1fffff
    buffer_load_dwordx4 v109, s[36:39], s17 offen lds
    s_add_u32 s17, s17, 32768
    s_waitcnt vmcnt(11)
    ds_read_b64_tr_b16 a[82:83], v111 offset:6144
    ds_read_b64_tr_b16 a[86:87], v111 offset:6152
    s_waitcnt lgkmcnt(6)
    s_add_u32 m0, s75, 3072
    s_and_b32 s17, s17, 0x1fffff
    buffer_load_dwordx4 v109, s[36:39], s17 offen lds
    s_add_u32 s17, s17, 32768
    s_waitcnt vmcnt(11)
    ds_read_b64_tr_b16 a[88:89], v111 offset:7168
    ds_read_b64_tr_b16 a[92:93], v111 offset:7176
    s_waitcnt lgkmcnt(6)
    s_add_u32 m0, s75, 4096
    s_and_b32 s17, s17, 0x1fffff
    buffer_load_dwordx4 v109, s[36:39], s17 offen lds
    s_add_u32 s17, s17, 32768
    s_waitcnt vmcnt(11)
    ds_read_b64_tr_b16 a[90:91], v111 offset:8192
    ds_read_b64_tr_b16 a[94:95], v111 offset:8200
    s_waitcnt lgkmcnt(6)
    s_add_u32 m0, s75, 5120
    s_and_b32 s17, s17, 0x1fffff
    buffer_load_dwordx4 v109, s[36:39], s17 offen lds
    s_add_u32 s17, s17, 32768
    s_waitcnt vmcnt(11)
    ds_read_b64_tr_b16 a[96:97], v111 offset:9216
    ds_read_b64_tr_b16 a[100:101], v111 offset:9224
    s_waitcnt lgkmcnt(6)
    s_add_u32 m0, s75, 6144
    s_and_b32 s17, s17, 0x1fffff
    buffer_load_dwordx4 v109, s[36:39], s17 offen lds
    s_add_u32 s17, s17, 32768
    s_waitcnt vmcnt(11)
    ds_read_b64_tr_b16 a[98:99], v111 offset:10240
    ds_read_b64_tr_b16 a[102:103], v111 offset:10248
    s_waitcnt lgkmcnt(6)
    s_add_u32 m0, s75, 7168
    s_and_b32 s17, s17, 0x1fffff
    buffer_load_dwordx4 v109, s[36:39], s17 offen lds
    s_add_u32 s17, s17, 32768
    s_waitcnt vmcnt(11)
    ds_read_b64_tr_b16 a[104:105], v111 offset:11264
    ds_read_b64_tr_b16 a[108:109], v111 offset:11272
    s_waitcnt lgkmcnt(6)
    s_add_u32 m0, s75, 8192
    s_and_b32 s17, s17, 0x1fffff
    buffer_load_dwordx4 v109, s[36:39], s17 offen lds
    s_add_u32 s17, s17, 32768
    s_waitcnt vmcnt(11)
    ds_read_b64_tr_b16 a[106:107], v111 offset:12288
    ds_read_b64_tr_b16 a[110:111], v111 offset:12296
    s_waitcnt lgkmcnt(6)
    s_add_u32 m0, s75, 9216
    s_and_b32 s17, s17, 0x1fffff
    buffer_load_dwordx4 v109, s[36:39], s17 offen lds
    s_add_u32 s17, s17, 32768
    s_waitcnt vmcnt(11)
    ds_read_b64_tr_b16 a[112:113], v111 offset:13312
    ds_read_b64_tr_b16 a[116:117], v111 offset:13320
    s_waitcnt lgkmcnt(6)
    s_add_u32 m0, s75, 10240
    s_and_b32 s17, s17, 0x1fffff
    buffer_load_dwordx4 v109, s[36:39], s17 offen lds
    s_add_u32 s17, s17, 32768
    s_waitcnt vmcnt(11)
    ds_read_b64_tr_b16 a[114:115], v111 offset:14336
    ds_read_b64_tr_b16 a[118:119], v111 offset:14344
    s_waitcnt lgkmcnt(6)
    s_add_u32 m0, s75, 11264
    s_and_b32 s17, s17, 0x1fffff
    buffer_load_dwordx4 v109, s[36:39], s17 offen lds
    s_add_u32 s17, s17, 32768
    s_waitcnt vmcnt(11)
    ds_read_b64_tr_b16 a[120:121], v111 offset:0
    ds_read_b64_tr_b16 a[124:125], v111 offset:8
    s_waitcnt lgkmcnt(6)
    s_add_u32 m0, s75, 12288
    s_and_b32 s17, s17, 0x1fffff
    buffer_load_dwordx4 v109, s[36:39], s17 offen lds
    s_add_u32 s17, s17, 32768
    s_waitcnt vmcnt(11)
    ds_read_b64_tr_b16 a[122:123], v111 offset:1024
    ds_read_b64_tr_b16 a[126:127], v111 offset:1032
    s_waitcnt lgkmcnt(6)
    s_add_u32 m0, s75, 13312
    s_and_b32 s17, s17, 0x1fffff
    buffer_load_dwordx4 v109, s[36:39], s17 offen lds
    s_add_u32 s17, s17, 32768
    s_waitcnt vmcnt(11)
    ds_read_b64_tr_b16 a[128:129], v111 offset:2048
    ds_read_b64_tr_b16 a[132:133], v111 offset:2056
    s_waitcnt lgkmcnt(6)
    s_add_u32 m0, s75, 14336
    s_and_b32 s17, s17, 0x1fffff
    buffer_load_dwordx4 v109, s[36:39], s17 offen lds
    s_add_u32 s17, s17, 32768
    s_waitcnt vmcnt(11)
    ds_read_b64_tr_b16 a[130:131], v111 offset:3072
    ds_read_b64_tr_b16 a[134:135], v111 offset:3080
    s_waitcnt lgkmcnt(6)
    s_add_u32 m0, s75, 0
    s_and_b32 s17, s17, 0x1fffff
    buffer_load_dwordx4 v109, s[36:39], s17 offen lds
    s_add_u32 s17, s17, 32768
    s_waitcnt vmcnt(11)
    ds_read_b64_tr_b16 a[136:137], v111 offset:4096
    ds_read_b64_tr_b16 a[140:141], v111 offset:4104
    s_waitcnt lgkmcnt(6)
    s_add_u32 m0, s75, 1024
    s_and_b32 s17, s17, 0x1fffff
    buffer_load_dwordx4 v109, s[36:39], s17 offen lds
    s_add_u32 s17, s17, 32768
    s_waitcnt vmcnt(11)
    ds_read_b64_tr_b16 a[138:139], v111 offset:5120
    ds_read_b64_tr_b16 a[142:143], v111 offset:5128
    s_waitcnt lgkmcnt(6)
    s_add_u32 m0, s75, 2048
    s_and_b32 s17, s17, 0x1fffff
    buffer_load_dwordx4 v109, s[36:39], s17 offen lds
    s_add_u32 s17, s17, 32768
    s_waitcnt vmcnt(11)
    ds_read_b64_tr_b16 a[144:145], v111 offset:6144
    ds_read_b64_tr_b16 a[148:149], v111 offset:6152
    s_waitcnt lgkmcnt(6)
    s_add_u32 m0, s75, 3072
    s_and_b32 s17, s17, 0x1fffff
    buffer_load_dwordx4 v109, s[36:39], s17 offen lds
    s_add_u32 s17, s17, 32768
    s_waitcnt vmcnt(11)
    ds_read_b64_tr_b16 a[146:147], v111 offset:7168
    ds_read_b64_tr_b16 a[150:151], v111 offset:7176
    s_waitcnt lgkmcnt(6)
    s_add_u32 m0, s75, 4096
    s_and_b32 s17, s17, 0x1fffff
    buffer_load_dwordx4 v109, s[36:39], s17 offen lds
    s_add_u32 s17, s17, 32768
    s_waitcnt vmcnt(11)
    ds_read_b64_tr_b16 a[152:153], v111 offset:8192
    ds_read_b64_tr_b16 a[156:157], v111 offset:8200
    s_waitcnt lgkmcnt(6)
    s_add_u32 m0, s75, 5120
    s_and_b32 s17, s17, 0x1fffff
    buffer_load_dwordx4 v109, s[36:39], s17 offen lds
    s_add_u32 s17, s17, 32768
    s_waitcnt vmcnt(11)
    ds_read_b64_tr_b16 a[154:155], v111 offset:9216
    ds_read_b64_tr_b16 a[158:159], v111 offset:9224
    s_waitcnt lgkmcnt(6)
    s_add_u32 m0, s75, 6144
    s_and_b32 s17, s17, 0x1fffff
    buffer_load_dwordx4 v109, s[36:39], s17 offen lds
    s_add_u32 s17, s17, 32768
    s_waitcnt vmcnt(11)
    ds_read_b64_tr_b16 a[160:161], v111 offset:10240
    ds_read_b64_tr_b16 a[164:165], v111 offset:10248
    s_waitcnt lgkmcnt(6)
    s_add_u32 m0, s75, 7168
    s_and_b32 s17, s17, 0x1fffff
    buffer_load_dwordx4 v109, s[36:39], s17 offen lds
    s_add_u32 s17, s17, 32768
    s_waitcnt vmcnt(11)
    ds_read_b64_tr_b16 a[162:163], v111 offset:11264
    ds_read_b64_tr_b16 a[166:167], v111 offset:11272
    s_waitcnt lgkmcnt(6)
    s_add_u32 m0, s75, 8192
    s_and_b32 s17, s17, 0x1fffff
    buffer_load_dwordx4 v109, s[36:39], s17 offen lds
    s_add_u32 s17, s17, 32768
    s_waitcnt vmcnt(11)
    ds_read_b64_tr_b16 a[168:169], v111 offset:12288
    ds_read_b64_tr_b16 a[172:173], v111 offset:12296
    s_waitcnt lgkmcnt(6)
    s_add_u32 m0, s75, 9216
    s_and_b32 s17, s17, 0x1fffff
    buffer_load_dwordx4 v109, s[36:39], s17 offen lds
    s_add_u32 s17, s17, 32768
    s_waitcnt vmcnt(11)
    ds_read_b64_tr_b16 a[170:171], v111 offset:13312
    ds_read_b64_tr_b16 a[174:175], v111 offset:13320
    s_waitcnt lgkmcnt(6)
    s_add_u32 m0, s75, 10240
    s_and_b32 s17, s17, 0x1fffff
    buffer_load_dwordx4 v109, s[36:39], s17 offen lds
    s_add_u32 s17, s17, 32768
    s_waitcnt vmcnt(11)
    ds_read_b64_tr_b16 a[176:177], v111 offset:14336
    ds_read_b64_tr_b16 a[180:181], v111 offset:14344
    s_waitcnt lgkmcnt(6)
    s_add_u32 m0, s75, 11264
    s_and_b32 s17, s17, 0x1fffff
    buffer_load_dwordx4 v109, s[36:39], s17 offen lds
    s_add_u32 s17, s17, 32768
    s_waitcnt vmcnt(11)
    ds_read_b64_tr_b16 a[178:179], v111 offset:0
    ds_read_b64_tr_b16 a[182:183], v111 offset:8
    s_waitcnt lgkmcnt(6)
    s_add_u32 m0, s75, 12288
    s_and_b32 s17, s17, 0x1fffff
    buffer_load_dwordx4 v109, s[36:39], s17 offen lds
    s_add_u32 s17, s17, 32768
    s_waitcnt vmcnt(11)
    ds_read_b64_tr_b16 a[184:185], v111 offset:1024
    ds_read_b64_tr_b16 a[188:189], v111 offset:1032
    s_waitcnt lgkmcnt(6)
    s_add_u32 m0, s75, 13312
    s_and_b32 s17, s17, 0x1fffff
    buffer_load_dwordx4 v109, s[36:39], s17 offen lds
    s_add_u32 s17, s17, 32768
    s_waitcnt vmcnt(11)
    ds_read_b64_tr_b16 a[186:187], v111 offset:2048
    ds_read_b64_tr_b16 a[190:191], v111 offset:2056
    s_waitcnt lgkmcnt(6)
    s_add_u32 m0, s75, 14336
    s_and_b32 s17, s17, 0x1fffff
    buffer_load_dwordx4 v109, s[36:39], s17 offen lds
    s_add_u32 s17, s17, 32768
    s_waitcnt vmcnt(11)
    ds_read_b64_tr_b16 a[192:193], v111 offset:3072
    ds_read_b64_tr_b16 a[196:197], v111 offset:3080
    s_waitcnt lgkmcnt(6)
    s_add_u32 m0, s75, 0
    s_and_b32 s17, s17, 0x1fffff
    buffer_load_dwordx4 v109, s[36:39], s17 offen lds
    s_add_u32 s17, s17, 32768
    s_waitcnt vmcnt(11)
    ds_read_b64_tr_b16 a[194:195], v111 offset:4096
    ds_read_b64_tr_b16 a[198:199], v111 offset:4104
    s_waitcnt lgkmcnt(6)
    s_add_u32 m0, s75, 1024
    s_and_b32 s17, s17, 0x1fffff
    buffer_load_dwordx4 v109, s[36:39], s17 offen lds
    s_add_u32 s17, s17, 32768
    s_waitcnt vmcnt(11)
    ds_read_b64_tr_b16 a[200:201], v111 offset:5120
    ds_read_b64_tr_b16 a[204:205], v111 offset:5128
    s_waitcnt lgkmcnt(6)
    s_add_u32 m0, s75, 2048
    s_and_b32 s17, s17, 0x1fffff
    buffer_load_dwordx4 v109, s[36:39], s17 offen lds
    s_add_u32 s17, s17, 32768
    s_waitcnt vmcnt(11)
    ds_read_b64_tr_b16 a[202:203], v111 offset:6144
    ds_read_b64_tr_b16 a[206:207], v111 offset:6152
    s_waitcnt lgkmcnt(6)
    s_add_u32 m0, s75, 3072
    s_and_b32 s17, s17, 0x1fffff
    buffer_load_dwordx4 v109, s[36:39], s17 offen lds
    s_add_u32 s17, s17, 32768
    s_setpc_b64 s[60:61]
L_skip:
    v_mfma_f32_16x16x32_bf16 v[0:3], v[176:179], v[208:211], v[0:3]
    ds_read_b128 v[144:147], v234 offset:0
    ds_read_b128 v[148:151], v234 offset:512
    v_mfma_f32_16x16x32_bf16 v[32:35], v[176:179], v[212:215], v[32:35]
    ds_read_b128 v[152:155], v234 offset:64
    v_exp_f32 v224, v80
    v_mfma_f32_16x16x32_bf16 v[36:39], v[180:183], v[212:215], v[36:39]
    ds_read_b128 v[156:159], v234 offset:576
    ds_read_b128 v[160:163], v234 offset:128
    v_mfma_f32_16x16x32_bf16 v[4:7], v[180:183], v[208:211], v[4:7]
    v_exp_f32 v225, v81
    v_mfma_f32_16x16x32_bf16 v[8:11], v[184:187], v[208:211], v[8:11]
    ds_read_b128 v[164:167], v234 offset:640
    ds_read_b128 v[168:171], v234 offset:192
    v_mfma_f32_16x16x32_bf16 v[40:43], v[184:187], v[212:215], v[40:43]
    s_add_u32 s72, s72, 16640
    v_exp_f32 v226, v82
    v_mfma_f32_16x16x32_bf16 v[44:47], v[188:191], v[212:215], v[44:47]
    s_cmp_eq_u32 s72, 149760
    ds_read_b64_tr_b16 v[176:177], v235 offset:0
    v_cvt_pk_bf16_f32 v216, v224, v225
    v_mfma_f32_16x16x32_bf16 v[12:15], v[188:191], v[208:211], v[12:15]
    s_cselect_b32 s72, 0, s72
    ds_read_b128 v[172:175], v234 offset:704
    ds_read_b64_tr_b16 v[178:179], v235 offset:512
    v_mfma_f32_16x16x32_bf16 v[16:19], v[192:195], v[208:211], v[16:19]
    v_exp_f32 v227, v83
    v_mfma_f32_16x16x32_bf16 v[48:51], v[192:195], v[212:215], v[48:51]
    ds_read_b64_tr_b16 v[180:181], v235 offset:32
    v_exp_f32 v228, v84
    v_mfma_f32_16x16x32_bf16 v[52:55], v[196:199], v[212:215], v[52:55]
    ds_read_b64_tr_b16 v[182:183], v235 offset:544
    v_cvt_pk_bf16_f32 v217, v226, v227
    v_mfma_f32_16x16x32_bf16 v[20:23], v[196:199], v[208:211], v[20:23]
    ds_read_b64_tr_b16 v[184:185], v235 offset:64
    v_exp_f32 v229, v85
    v_mfma_f32_16x16x32_bf16 v[24:27], v[200:203], v[208:211], v[24:27]
    ds_read_b64_tr_b16 v[186:187], v235 offset:576
    v_exp_f32 v230, v86
    v_mfma_f32_16x16x32_bf16 v[56:59], v[200:203], v[212:215], v[56:59]
    ds_read_b64_tr_b16 v[188:189], v235 offset:96
    v_cvt_pk_bf16_f32 v218, v228, v229
    v_mfma_f32_16x16x32_bf16 v[60:63], v[204:207], v[212:215], v[60:63]
    ds_read_b64_tr_b16 v[190:191], v235 offset:608
    v_exp_f32 v231, v87
    v_mfma_f32_16x16x32_bf16 v[28:31], v[204:207], v[208:211], v[28:31]
    ds_read_b64_tr_b16 v[192:193], v235 offset:128
    v_or3_b32 v249, v216, v217, v218
    v_mfma_f32_16x16x32_bf16 v[240:243], v[104:107], v[208:211], v[240:243]
    v_exp_f32 v224, v88
    v_mfma_f32_16x16x32_bf16 v[244:247], v[104:107], v[212:215], v[244:247]
    s_waitcnt lgkmcnt(8)
    ds_read_b64_tr_b16 v[194:195], v235 offset:640
    v_cvt_pk_bf16_f32 v219, v230, v231
    v_mfma_f32_16x16x32_bf16 v[64:67], v[144:147], v[112:115], v[96:99]
    s_add_u32 s16, s16, 1
    v_exp_f32 v225, v89
    v_mfma_f32_16x16x32_bf16 v[72:75], v[144:147], v[128:131], v[100:103]
    s_cmp_lt_u32 s16, s69
    ds_read_b64_tr_b16 v[196:197], v235 offset:160
    ds_read_b64_tr_b16 v[198:199], v235 offset:672
    v_mfma_f32_16x16x32_bf16 v[76:79], v[148:151], v[128:131], v[100:103]
    v_exp_f32 v226, v90
    v_mfma_f32_16x16x32_bf16 v[68:71], v[148:151], v[112:115], v[96:99]
    ds_read_b64_tr_b16 v[200:201], v235 offset:192
    v_cvt_pk_bf16_f32 v220, v224, v225
    v_mfma_f32_16x16x32_bf16 v[64:67], v[152:155], v[116:119], v[64:67]
    v_exp_f32 v227, v91
    v_mfma_f32_16x16x32_bf16 v[72:75], v[152:155], v[132:135], v[72:75]
    ds_read_b64_tr_b16 v[202:203], v235 offset:704
    v_or3_b32 v249, v249, v219, v220
    v_mfma_f32_16x16x32_bf16 v[76:79], v[156:159], v[132:135], v[76:79]
    ds_read_b64_tr_b16 v[204:205], v235 offset:224
    v_exp_f32 v228, v92
    v_mfma_f32_16x16x32_bf16 v[68:71], v[156:159], v[116:119], v[68:71]
    ds_read_b64_tr_b16 v[206:207], v235 offset:736
    v_cvt_pk_bf16_f32 v221, v226, v227
    v_mfma_f32_16x16x32_bf16 v[64:67], v[160:163], v[120:123], v[64:67]
    v_exp_f32 v229, v93
    v_mfma_f32_16x16x32_bf16 v[72:75], v[160:163], v[136:139], v[72:75]
    v_exp_f32 v230, v94
    v_mfma_f32_16x16x32_bf16 v[76:79], v[164:167], v[136:139], v[76:79]
    v_cvt_pk_bf16_f32 v222, v228, v229
    v_exp_f32 v231, v95
    v_mfma_f32_16x16x32_bf16 v[68:71], v[164:167], v[120:123], v[68:71]
    v_or3_b32 v249, v249, v221, v222
    v_add_u32 v234, s72, v232
    v_mfma_f32_16x16x32_bf16 v[64:67], v[168:171], v[124:127], v[64:67]
    v_cvt_pk_bf16_f32 v223, v230, v231
    v_bitop3_b32 v249, v249, v223, s74 bitop3:0xa8
    v_mfma_f32_16x16x32_bf16 v[72:75], v[168:171], v[140:143], v[72:75]
    v_cmp_ne_u32 vcc, 0, v249
    v_add_u32 v235, s72, v233
    v_mfma_f32_16x16x32_bf16 v[76:79], v[172:175], v[140:143], v[76:79]
    v_mfma_f32_16x16x32_bf16 v[68:71], v[172:175], v[124:127], v[68:71]
    s_cbranch_vccnz L_rare_bs
L_back_bs:
    s_waitcnt vmcnt(4) lgkmcnt(0)
    s_barrier
    s_cbranch_scc1 L_dispatch
    s_branch L_peel
L_rare_ea:
    s_call_b64 s[60:61], L_resc_0
    s_branch L_back_ea
L_rare_eb:
    s_call_b64 s[60:61], L_resc_1
    s_branch L_back_eb
L_rare_ca0:
    s_call_b64 s[60:61], L_resc_0
    s_branch L_back_ca0
L_rare_cb0:
    s_call_b64 s[60:61], L_resc_1
    s_branch L_back_cb0
L_rare_a3:
    s_call_b64 s[60:61], L_resc_0
    s_branch L_back_a3
L_rare_b3:
    s_call_b64 s[60:61], L_resc_1
    s_branch L_back_b3
L_rare_bs:
    s_call_b64 s[60:61], L_resc_1
    s_branch L_back_bs
L_resc_0:
    v_max3_f32 v250, v64, v65, v66
    v_max3_f32 v251, v67, v68, v69
    v_max3_f32 v250, v250, v70, v71
    v_max_f32 v250, v250, v251
    v_mov_b32 v251, v250
    s_nop 1
    v_permlane16_swap_b32 v251, v250
    v_max_f32 v250, v250, v251
    v_mov_b32 v251, v250
    s_nop 1
    v_permlane32_swap_b32 v251, v250
    v_max_f32 v250, v250, v251
    v_add_f32 v250, 0x41600000, v250
    v_max_f32 v250, 0, v250
    v_sub_f32 v251, 0, v250
    v_exp_f32 v251, v251
    v_sub_f32 v64, v64, v250
    v_sub_f32 v65, v65, v250
    v_sub_f32 v66, v66, v250
    v_sub_f32 v67, v67, v250
    v_sub_f32 v68, v68, v250
    v_sub_f32 v69, v69, v250
    v_sub_f32 v70, v70, v250
    v_sub_f32 v71, v71, v250
    v_sub_f32 v96, v96, v250
    v_sub_f32 v97, v97, v250
    v_sub_f32 v98, v98, v250
    v_sub_f32 v99, v99, v250
    v_sub_f32 v80, v80, v250
    v_sub_f32 v81, v81, v250
    v_sub_f32 v82, v82, v250
    v_sub_f32 v83, v83, v250
    v_sub_f32 v84, v84, v250
    v_sub_f32 v85, v85, v250
    v_sub_f32 v86, v86, v250
    v_sub_f32 v87, v87, v250
    v_mul_f32 v240, v240, v251
    v_mul_f32 v241, v241, v251
    v_mul_f32 v242, v242, v251
    v_mul_f32 v243, v243, v251
    v_mul_f32 v0, v0, v251
    v_mul_f32 v1, v1, v251
    v_mul_f32 v2, v2, v251
    v_mul_f32 v3, v3, v251
    v_mul_f32 v4, v4, v251
    v_mul_f32 v5, v5, v251
    v_mul_f32 v6, v6, v251
    v_mul_f32 v7, v7, v251
    v_mul_f32 v8, v8, v251
    v_mul_f32 v9, v9, v251
    v_mul_f32 v10, v10, v251
    v_mul_f32 v11, v11, v251
    v_mul_f32 v12, v12, v251
    v_mul_f32 v13, v13, v251
    v_mul_f32 v14, v14, v251
    v_mul_f32 v15, v15, v251
    v_mul_f32 v16, v16, v251
    v_mul_f32 v17, v17, v251
    v_mul_f32 v18, v18, v251
    v_mul_f32 v19, v19, v251
    v_mul_f32 v20, v20, v251
    v_mul_f32 v21, v21, v251
    v_mul_f32 v22, v22, v251
    v_mul_f32 v23, v23, v251
    v_mul_f32 v24, v24, v251
    v_mul_f32 v25, v25, v251
    v_mul_f32 v26, v26, v251
    v_mul_f32 v27, v27, v251
    v_mul_f32 v28, v28, v251
    v_mul_f32 v29, v29, v251
    v_mul_f32 v30, v30, v251
    v_mul_f32 v31, v31, v251
    v_max3_f32 v250, v72, v73, v74
    v_max3_f32 v251, v75, v76, v77
    v_max3_f32 v250, v250, v78, v79
    v_max_f32 v250, v250, v251
    v_mov_b32 v251, v250
    s_nop 1
    v_permlane16_swap_b32 v251, v250
    v_max_f32 v250, v250, v251
    v_mov_b32 v251, v250
    s_nop 1
    v_permlane32_swap_b32 v251, v250
    v_max_f32 v250, v250, v251
    v_add_f32 v250, 0x41600000, v250
    v_max_f32 v250, 0, v250
    v_sub_f32 v251, 0, v250
    v_exp_f32 v251, v251
    v_sub_f32 v72, v72, v250
    v_sub_f32 v73, v73, v250
    v_sub_f32 v74, v74, v250
    v_sub_f32 v75, v75, v250
    v_sub_f32 v76, v76, v250
    v_sub_f32 v77, v77, v250
    v_sub_f32 v78, v78, v250
    v_sub_f32 v79, v79, v250
    v_sub_f32 v100, v100, v250
    v_sub_f32 v101, v101, v250
    v_sub_f32 v102, v102, v250
    v_sub_f32 v103, v103, v250
    v_sub_f32 v88, v88, v250
    v_sub_f32 v89, v89, v250
    v_sub_f32 v90, v90, v250
    v_sub_f32 v91, v91, v250
    v_sub_f32 v92, v92, v250
    v_sub_f32 v93, v93, v250
    v_sub_f32 v94, v94, v250
    v_sub_f32 v95, v95, v250
    v_mul_f32 v244, v244, v251
    v_mul_f32 v245, v245, v251
    v_mul_f32 v246, v246, v251
    v_mul_f32 v247, v247, v251
    v_mul_f32 v32, v32, v251
    v_mul_f32 v33, v33, v251
    v_mul_f32 v34, v34, v251
    v_mul_f32 v35, v35, v251
    v_mul_f32 v36, v36, v251
    v_mul_f32 v37, v37, v251
    v_mul_f32 v38, v38, v251
    v_mul_f32 v39, v39, v251
    v_mul_f32 v40, v40, v251
    v_mul_f32 v41, v41, v251
    v_mul_f32 v42, v42, v251
    v_mul_f32 v43, v43, v251
    v_mul_f32 v44, v44, v251
    v_mul_f32 v45, v45, v251
    v_mul_f32 v46, v46, v251
    v_mul_f32 v47, v47, v251
    v_mul_f32 v48, v48, v251
    v_mul_f32 v49, v49, v251
    v_mul_f32 v50, v50, v251
    v_mul_f32 v51, v51, v251
    v_mul_f32 v52, v52, v251
    v_mul_f32 v53, v53, v251
    v_mul_f32 v54, v54, v251
    v_mul_f32 v55, v55, v251
    v_mul_f32 v56, v56, v251
    v_mul_f32 v57, v57, v251
    v_mul_f32 v58, v58, v251
    v_mul_f32 v59, v59, v251
    v_mul_f32 v60, v60, v251
    v_mul_f32 v61, v61, v251
    v_mul_f32 v62, v62, v251
    v_mul_f32 v63, v63, v251
    v_exp_f32 v224, v64
    v_exp_f32 v225, v65
    s_nop 0
    v_cvt_pk_bf16_f32 v208, v224, v225
    v_exp_f32 v226, v66
    v_exp_f32 v227, v67
    s_nop 0
    v_cvt_pk_bf16_f32 v209, v226, v227
    v_exp_f32 v228, v68
    v_exp_f32 v229, v69
    s_nop 0
    v_cvt_pk_bf16_f32 v210, v228, v229
    v_exp_f32 v230, v70
    v_exp_f32 v231, v71
    s_nop 0
    v_cvt_pk_bf16_f32 v211, v230, v231
    v_exp_f32 v224, v72
    v_exp_f32 v225, v73
    s_nop 0
    v_cvt_pk_bf16_f32 v212, v224, v225
    v_exp_f32 v226, v74
    v_exp_f32 v227, v75
    s_nop 0
    v_cvt_pk_bf16_f32 v213, v226, v227
    v_exp_f32 v228, v76
    v_exp_f32 v229, v77
    s_nop 0
    v_cvt_pk_bf16_f32 v214, v228, v229
    v_exp_f32 v230, v78
    v_exp_f32 v231, v79
    s_nop 0
    v_cvt_pk_bf16_f32 v215, v230, v231
    s_nop 0
    s_setpc_b64 s[60:61]
L_resc_1:
    v_max3_f32 v250, v80, v81, v82
    v_max3_f32 v251, v83, v84, v85
    v_max3_f32 v250, v250, v86, v87
    v_max_f32 v250, v250, v251
    v_mov_b32 v251, v250
    s_nop 1
    v_permlane16_swap_b32 v251, v250
    v_max_f32 v250, v250, v251
    v_mov_b32 v251, v250
    s_nop 1
    v_permlane32_swap_b32 v251, v250
    v_max_f32 v250, v250, v251
    v_add_f32 v250, 0x41600000, v250
    v_max_f32 v250, 0, v250
    v_sub_f32 v251, 0, v250
    v_exp_f32 v251, v251
    v_sub_f32 v80, v80, v250
    v_sub_f32 v81, v81, v250
    v_sub_f32 v82, v82, v250
    v_sub_f32 v83, v83, v250
    v_sub_f32 v84, v84, v250
    v_sub_f32 v85, v85, v250
    v_sub_f32 v86, v86, v250
    v_sub_f32 v87, v87, v250
    v_sub_f32 v96, v96, v250
    v_sub_f32 v97, v97, v250
    v_sub_f32 v98, v98, v250
    v_sub_f32 v99, v99, v250
    v_sub_f32 v64, v64, v250
    v_sub_f32 v65, v65, v250
    v_sub_f32 v66, v66, v250
    v_sub_f32 v67, v67, v250
    v_sub_f32 v68, v68, v250
    v_sub_f32 v69, v69, v250
    v_sub_f32 v70, v70, v250
    v_sub_f32 v71, v71, v250
    v_mul_f32 v240, v240, v251
    v_mul_f32 v241, v241, v251
    v_mul_f32 v242, v242, v251
    v_mul_f32 v243, v243, v251
    v_mul_f32 v0, v0, v251
    v_mul_f32 v1, v1, v251
    v_mul_f32 v2, v2, v251
    v_mul_f32 v3, v3, v251
    v_mul_f32 v4, v4, v251
    v_mul_f32 v5, v5, v251
    v_mul_f32 v6, v6, v251
    v_mul_f32 v7, v7, v251
    v_mul_f32 v8, v8, v251
    v_mul_f32 v9, v9, v251
    v_mul_f32 v10, v10, v251
    v_mul_f32 v11, v11, v251
    v_mul_f32 v12, v12, v251
    v_mul_f32 v13, v13, v251
    v_mul_f32 v14, v14, v251
    v_mul_f32 v15, v15, v251
    v_mul_f32 v16, v16, v251
    v_mul_f32 v17, v17, v251
    v_mul_f32 v18, v18, v251
    v_mul_f32 v19, v19, v251
    v_mul_f32 v20, v20, v251
    v_mul_f32 v21, v21, v251
    v_mul_f32 v22, v22, v251
    v_mul_f32 v23, v23, v251
    v_mul_f32 v24, v24, v251
    v_mul_f32 v25, v25, v251
    v_mul_f32 v26, v26, v251
    v_mul_f32 v27, v27, v251
    v_mul_f32 v28, v28, v251
    v_mul_f32 v29, v29, v251
    v_mul_f32 v30, v30, v251
    v_mul_f32 v31, v31, v251
    v_max3_f32 v250, v88, v89, v90
    v_max3_f32 v251, v91, v92, v93
    v_max3_f32 v250, v250, v94, v95
    v_max_f32 v250, v250, v251
    v_mov_b32 v251, v250
    s_nop 1
    v_permlane16_swap_b32 v251, v250
    v_max_f32 v250, v250, v251
    v_mov_b32 v251, v250
    s_nop 1
    v_permlane32_swap_b32 v251, v250
    v_max_f32 v250, v250, v251
    v_add_f32 v250, 0x41600000, v250
    v_max_f32 v250, 0, v250
    v_sub_f32 v251, 0, v250
    v_exp_f32 v251, v251
    v_sub_f32 v88, v88, v250
    v_sub_f32 v89, v89, v250
    v_sub_f32 v90, v90, v250
    v_sub_f32 v91, v91, v250
    v_sub_f32 v92, v92, v250
    v_sub_f32 v93, v93, v250
    v_sub_f32 v94, v94, v250
    v_sub_f32 v95, v95, v250
    v_sub_f32 v100, v100, v250
    v_sub_f32 v101, v101, v250
    v_sub_f32 v102, v102, v250
    v_sub_f32 v103, v103, v250
    v_sub_f32 v72, v72, v250
    v_sub_f32 v73, v73, v250
    v_sub_f32 v74, v74, v250
    v_sub_f32 v75, v75, v250
    v_sub_f32 v76, v76, v250
    v_sub_f32 v77, v77, v250
    v_sub_f32 v78, v78, v250
    v_sub_f32 v79, v79, v250
    v_mul_f32 v244, v244, v251
    v_mul_f32 v245, v245, v251
    v_mul_f32 v246, v246, v251
    v_mul_f32 v247, v247, v251
    v_mul_f32 v32, v32, v251
    v_mul_f32 v33, v33, v251
    v_mul_f32 v34, v34, v251
    v_mul_f32 v35, v35, v251
    v_mul_f32 v36, v36, v251
    v_mul_f32 v37, v37, v251
    v_mul_f32 v38, v38, v251
    v_mul_f32 v39, v39, v251
    v_mul_f32 v40, v40, v251
    v_mul_f32 v41, v41, v251
    v_mul_f32 v42, v42, v251
    v_mul_f32 v43, v43, v251
    v_mul_f32 v44, v44, v251
    v_mul_f32 v45, v45, v251
    v_mul_f32 v46, v46, v251
    v_mul_f32 v47, v47, v251
    v_mul_f32 v48, v48, v251
    v_mul_f32 v49, v49, v251
    v_mul_f32 v50, v50, v251
    v_mul_f32 v51, v51, v251
    v_mul_f32 v52, v52, v251
    v_mul_f32 v53, v53, v251
    v_mul_f32 v54, v54, v251
    v_mul_f32 v55, v55, v251
    v_mul_f32 v56, v56, v251
    v_mul_f32 v57, v57, v251
    v_mul_f32 v58, v58, v251
    v_mul_f32 v59, v59, v251
    v_mul_f32 v60, v60, v251
    v_mul_f32 v61, v61, v251
    v_mul_f32 v62, v62, v251
    v_mul_f32 v63, v63, v251
    v_exp_f32 v224, v80
    v_exp_f32 v225, v81
    s_nop 0
    v_cvt_pk_bf16_f32 v216, v224, v225
    v_exp_f32 v226, v82
    v_exp_f32 v227, v83
    s_nop 0
    v_cvt_pk_bf16_f32 v217, v226, v227
    v_exp_f32 v228, v84
    v_exp_f32 v229, v85
    s_nop 0
    v_cvt_pk_bf16_f32 v218, v228, v229
    v_exp_f32 v230, v86
    v_exp_f32 v231, v87
    s_nop 0
    v_cvt_pk_bf16_f32 v219, v230, v231
    v_exp_f32 v224, v88
    v_exp_f32 v225, v89
    s_nop 0
    v_cvt_pk_bf16_f32 v220, v224, v225
    v_exp_f32 v226, v90
    v_exp_f32 v227, v91
    s_nop 0
    v_cvt_pk_bf16_f32 v221, v226, v227
    v_exp_f32 v228, v92
    v_exp_f32 v229, v93
    s_nop 0
    v_cvt_pk_bf16_f32 v222, v228, v229
    v_exp_f32 v230, v94
    v_exp_f32 v231, v95
    s_nop 0
    v_cvt_pk_bf16_f32 v223, v230, v231
    s_nop 0
    s_setpc_b64 s[60:61]
L_code_end:
.fill 64, 4, 0xbf800000
.section .rodata,"a"
.p2align 6
.amdhsa_kernel standalone__gqa_block_cached__sampling_kernel
      .amdhsa_next_free_vgpr 512
      .amdhsa_next_free_sgpr 102
      .amdhsa_accum_offset 256
      .amdhsa_group_segment_fixed_size 0
      .amdhsa_kernarg_size 64
      .amdhsa_user_sgpr_count 2
      .amdhsa_user_sgpr_kernarg_segment_ptr 1
      .amdhsa_system_sgpr_workgroup_id_x 1
.end_amdhsa_kernel
```
